```python
import torch

def _softmax(x, axis=-1):
    return torch.softmax(x, dim=axis)

def _gelu(x):
    return torch.nn.functional.gelu(x, approximate='tanh')

def _silu(x):
    return torch.nn.functional.silu(x)

def _sigmoid(x):
    return torch.sigmoid(x)

def _layernorm(x, axis=-1, eps=1e-05):
    m = x.mean(dim=axis, keepdim=True)
    v = x.var(dim=axis, keepdim=True, unbiased=False)
    return (x - m) / torch.sqrt(v + eps)

def _scatter_add(tgt, idx, src, axis=0):
    return tgt.clone().index_add_(axis, idx, src)

def _segment_sum(src, seg, n):
    out = torch.zeros((n,) + src.shape[1:], dtype=src.dtype)
    return out.index_add_(0, seg, src)

def _pad(x, pw):
    flat = tuple((v for pair in reversed(pw) for v in pair))
    return torch.nn.functional.pad(x, flat)
kernel_name = 'adaLN_cond__linear_kernel_hedgehog__glu_gated_glu__prompt'

def setup_inputs():

    _w = lambda a: (lambda t: t.to(torch.bfloat16) if t.is_floating_point() else t)(torch.as_tensor(a))

    def _A_setup():
        B, S, D, H = (1, 2048, 512, 32)
        Dh = D // H
        return {'x': _w((lambda *s: torch.randn(*s, dtype=torch.bfloat16) * 0.05)(B, S, D)), 'wqkv': _w((lambda *s: torch.randn(*s, dtype=torch.bfloat16) * 0.4)(D, 3 * D)), 'w_phi': _w((lambda *s: torch.randn(*s, dtype=torch.bfloat16) * 0.4)(H, Dh, Dh) * Dh ** (-0.5)), 'wo': _w((lambda *s: torch.randn(*s, dtype=torch.bfloat16) * 0.05)(D, D))}
    _A_in = _A_setup()

    def _B_setup():
        B, S, D, F = (1, 2048, 512, 1376)
        return {'x': _w((lambda *s: torch.randn(*s, dtype=torch.bfloat16) * 0.05)(B, S, D)), 'w_gate': _w((lambda *s: torch.randn(*s, dtype=torch.bfloat16) * 0.1)(D, F)), 'w_up': _w((lambda *s: torch.randn(*s, dtype=torch.bfloat16) * 0.05)(D, F)), 'w_down': _w((lambda *s: torch.randn(*s, dtype=torch.bfloat16) * 0.05)(F, D))}
    _B_in = _B_setup()
    return {'A_x': _A_in['x'], 'A_wqkv': _A_in['wqkv'], 'A_w_phi': _A_in['w_phi'], 'A_wo': _A_in['wo'], 'B_x': _B_in['x'], 'B_w_gate': _B_in['w_gate'], 'B_w_up': _B_in['w_up'], 'B_w_down': _B_in['w_down'], 'c': _w((lambda *s: torch.randn(*s, dtype=torch.bfloat16) * 0.2)(1, 512) * 8.0), 'w_mod': _w((lambda *s: torch.randn(*s, dtype=torch.bfloat16) * 0.2)(512, 6 * 512) * 512 ** (-0.5) * 8.0)}

def reference(A_x, A_wqkv, A_w_phi, A_wo, B_x, B_w_gate, B_w_up, B_w_down, c, w_mod):

    def _A_ref(x, wqkv, w_phi, wo):
        B, S, D = x.shape
        H = 32
        Dh = D // H
        qkv = (lambda x, *d: x.permute(*d))((x @ wqkv).reshape(B, S, 3, H, Dh), 2, 0, 3, 1, 4)
        q, k, v = (qkv[0], qkv[1], qkv[2])
        pq = torch.einsum('bhsd,hdf->bhsf', q, w_phi)
        pk = torch.einsum('bhsd,hdf->bhsf', k, w_phi)
        phi_q = torch.concatenate([_softmax(pq, axis=-1), _softmax(-pq, axis=-1)], axis=-1)
        phi_k = torch.concatenate([_softmax(pk, axis=-1), _softmax(-pk, axis=-1)], axis=-1)
        kv = torch.einsum('bhsf,bhsd->bhfd', phi_k, v)
        z = torch.einsum('bhsf->bhf', phi_k)
        num = torch.einsum('bhqf,bhfd->bhqd', phi_q, kv)
        den = torch.einsum('bhqf,bhf->bhq', phi_q, z)[..., None] + 1e-06
        o = num / den
        return (lambda x, *d: x.permute(*d))(o, 0, 2, 1, 3).reshape(B, S, D) @ wo

    def _B_ref(x, w_gate, w_up, w_down):
        g = torch.einsum('bsd,df->bsf', x, w_gate)
        u = torch.einsum('bsd,df->bsf', x, w_up)
        h = _sigmoid(g) * u
        return torch.einsum('bsf,fd->bsd', h, w_down)
    x = A_x
    mod = (_silu(c) @ w_mod).reshape(c.shape[0], 6, 1, -1)
    sa, ca, ga, sb, cb, gb = (mod[:, 0].clone(), mod[:, 1].clone(), mod[:, 2].clone(), mod[:, 3].clone(), mod[:, 4].clone(), mod[:, 5].clone())
    h = _layernorm(x, axis=-1) * (1 + ca) + sa
    x = x + ga * _A_ref(h, A_wqkv, A_w_phi, A_wo)
    h = _layernorm(x, axis=-1) * (1 + cb) + sb
    x = x + gb * _B_ref(h, B_w_gate, B_w_up, B_w_down)
    return x
```

```asm
; @launch grid=(256,1,1) block=(256,1,1) lds=163840
.amdgcn_target "amdgcn-amd-amdhsa--gfx950"
.text
.globl adaLN_cond__linear_kernel_hedgehog__glu_gated_glu__prompt_kernel
.p2align 8
.type adaLN_cond__linear_kernel_hedgehog__glu_gated_glu__prompt_kernel,@function
adaLN_cond__linear_kernel_hedgehog__glu_gated_glu__prompt_kernel:
  s_cmp_ge_u32 s2, 256
  s_cbranch_scc1 L_end
  s_load_dwordx2 s[8:9], s[0:1], 0
  s_load_dwordx2 s[40:41], s[0:1], 72
  s_load_dwordx2 s[36:37], s[0:1], 64
  s_load_dwordx2 s[48:49], s[0:1], 96
  s_load_dwordx2 s[12:13], s[0:1], 8
  s_getpc_b64 s[4:5]
L_pc:
  s_lshr_b32 s52, s2, 3
  s_mul_i32 s6, s52, 1024
  v_lshlrev_b32 v254, 7, v0
  v_add_u32 v254, s6, v254
  v_cmp_gt_u32 vcc, 8, v0
  s_nop 0
  s_and_saveexec_b64 s[6:7], vcc
  s_cbranch_execz L_npf
  global_load_dword v255, v254, s[4:5]
L_npf:
  s_mov_b64 exec, -1
  v_and_b32 v1, 63, v0
  v_lshrrev_b32 v3, 6, v0
  s_and_b32 s66, s2, 7
  v_readfirstlane_b32 s60, v3
  s_lshr_b32 s68, s52, 4
  s_lshl_b32 s58, s66, 1
  s_add_u32 s58, s58, s68
  s_and_b32 s59, s52, 15
  s_mov_b32 s10, 2097152
  s_mov_b32 s11, 0x00020000
  s_mov_b32 s42, 3145728
  s_mov_b32 s43, 0x00020000
  s_mov_b32 s38, 1024
  s_mov_b32 s39, 0x00020000
  s_lshr_b32 s67, s52, 2
  s_lshl_b32 s68, s66, 1
  s_add_u32 s68, s68, s67
  s_lshl_b32 s69, s66, 2
  s_add_u32 s69, s69, s67
  s_add_u32 s69, s69, 14
  s_cmp_lt_u32 s52, 8
  s_cselect_b32 s70, s68, s69
  s_and_b32 s71, s52, 3
  v_lshlrev_b32 v2, 4, v1
  v_and_b32 v4, 3, v1
  v_lshrrev_b32 v6, 2, v1
  v_lshrrev_b32 v3, 5, v1
  v_lshrrev_b32 v7, 3, v1
  v_and_b32 v9, 7, v1
  v_mul_u32_u24 v252, 6144, v7
  v_lshl_add_u32 v252, v9, 4, v252
  v_lshlrev_b32 v253, 2, v1
  s_lshl2_add_u32 s96, s71, s60
  s_mul_i32 s96, s96, 196608
  s_lshl_b32 s68, s70, 7
  s_add_u32 s96, s96, s68
  s_lshl_b32 s97, s71, 8
  s_mul_i32 s98, s71, 12288
  s_lshl2_add_u32 s68, s70, s60
  s_lshl_b32 s68, s68, 6
  s_add_u32 s98, s98, s68
  s_add_u32 s98, s98, 606208
  v_and_b32 v11, 15, v1
  v_lshrrev_b32 v5, 4, v1
  v_lshlrev_b32 v5, 10, v5
  v_lshl_add_u32 v5, v11, 4, v5
  v_and_b32 v11, 31, v1
  v_lshlrev_b32 v11, 10, v11
  v_lshl_add_u32 v11, v3, 4, v11
  s_lshl_b32 s66, s58, 17
  s_lshl_b32 s72, s59, 13
  s_add_u32 s72, s72, s66
  s_lshl_b32 s73, s60, 12
  s_add_u32 s72, s72, s73
  s_lshl_b32 s73, s60, 15
  s_add_u32 s73, s73, s66
  s_lshl_b32 s66, s59, 6
  s_add_u32 s73, s73, s66
  s_lshl_b32 s54, s60, 10
  s_waitcnt lgkmcnt(0)
  s_cmp_gt_u32 s60, 1
  s_cbranch_scc1 C_1
  buffer_load_dwordx4 v[208:211], v5, s[8:11], s72 offen offset:0
  buffer_load_dwordx4 v[212:215], v5, s[8:11], s72 offen offset:256
  buffer_load_dwordx4 v[216:219], v5, s[8:11], s72 offen offset:512
  buffer_load_dwordx4 v[220:223], v5, s[8:11], s72 offen offset:768
C_1:
  s_cmp_ge_u32 s52, 8
  s_cbranch_scc1 C_2
  buffer_load_dword v250, v253, s[36:39], s97 offen
  s_lshl2_add_u32 m0, s54, 139264
  s_add_u32 s55, s96, 0
  buffer_load_dwordx4 v252, s[40:43], s55 offen lds
  s_lshl2_add_u32 m0, s54, 140288
  s_add_u32 s55, s96, 49152
  buffer_load_dwordx4 v252, s[40:43], s55 offen lds
  s_lshl2_add_u32 m0, s54, 141312
  s_add_u32 s55, s96, 98304
  buffer_load_dwordx4 v252, s[40:43], s55 offen lds
  s_lshl2_add_u32 m0, s54, 142336
  s_add_u32 s55, s96, 147456
  buffer_load_dwordx4 v252, s[40:43], s55 offen lds
C_2:
  s_mov_b32 s53, s73
  buffer_load_dwordx4 v[184:187], v11, s[8:11], s53 offen
  buffer_load_dwordx4 v[188:191], v11, s[8:11], s53 offen offset:32
  s_load_dword s56, s[48:49], 0
  s_load_dwordx2 s[16:17], s[0:1], 16
  s_load_dwordx2 s[20:21], s[0:1], 24
  s_load_dwordx2 s[24:25], s[0:1], 40
  s_load_dwordx2 s[28:29], s[0:1], 48
  s_load_dwordx2 s[32:33], s[0:1], 56
  s_load_dwordx2 s[44:45], s[0:1], 80
  s_lshl_b32 s66, s59, 6
  v_mul_u32_u24 v12, 3072, v6
  v_lshl_add_u32 v12, v4, 4, v12
  v_add_u32 v15, 49152, v12
  v_add_u32 v16, 393216, v12
  v_add_u32 v17, 442368, v12
  s_mul_i32 s55, s60, 393216
  s_add_u32 s55, s55, s66
  s_lshr_b32 s66, s52, 3
  s_and_b32 s66, s66, 2
  s_and_b32 s86, s52, 1
  s_or_b32 s66, s66, s86
  s_xor_b32 s82, s66, 0
  s_mul_i32 s82, s82, 98304
  s_add_u32 s82, s82, s55
  s_xor_b32 s83, s66, 1
  s_mul_i32 s83, s83, 98304
  s_add_u32 s83, s83, s55
  s_xor_b32 s84, s66, 2
  s_mul_i32 s84, s84, 98304
  s_add_u32 s84, s84, s55
  s_xor_b32 s85, s66, 3
  s_mul_i32 s85, s85, 98304
  s_add_u32 s85, s85, s55
  s_lshl_b32 s66, s66, 11
  s_lshl_b32 s86, s60, 13
  s_xor_b32 s86, s86, s66
  s_sub_u32 s71, s60, 2
  s_lshl_b32 s71, s71, 14
  s_xor_b32 s71, s71, s66
  s_sub_u32 s70, s60, 4
  s_mul_i32 s70, s70, 393216
  s_add_u32 s70, s70, 1024
  s_add_u32 s66, s82, s70
  s_add_u32 s67, s83, s70
  s_add_u32 s68, s84, s70
  s_add_u32 s69, s85, s70
  s_mov_b32 s50, 268435456
  s_mov_b32 s51, 0x00020000
  s_mov_b32 s14, 1572864
  s_mov_b32 s15, 0x00020000
  s_mov_b32 s18, 16384
  s_mov_b32 s19, 0x00020000
  s_mov_b32 s22, 524288
  s_mov_b32 s23, 0x00020000
  s_mov_b32 s26, 1409024
  s_mov_b32 s27, 0x00020000
  s_mov_b32 s30, 1409024
  s_mov_b32 s31, 0x00020000
  s_mov_b32 s34, 1409024
  s_mov_b32 s35, 0x00020000
  s_mov_b32 s46, 2097152
  s_mov_b32 s47, 0x00020000
  s_getreg_b32 s61, hwreg(HW_REG_XCC_ID)
  s_lshl_b32 s62, s58, 11
  s_add_u32 s62, s62, 49152
  s_cmp_ge_u32 s52, 8
  s_cbranch_scc1 C_3
  s_lshl_b32 s70, s60, 8
  s_add_u32 s70, s70, 107520
  v_add_u32 v144, s70, v253
  v_and_b32 v145, 48, v1
  v_add_u32 v145, s70, v145
  v_lshrrev_b32 v146, 4, v1
  v_bfe_u32 v147, v1, 2, 2
  v_lshl_add_u32 v146, v146, 3, v147
  v_lshlrev_b32 v146, 7, v146
  v_and_b32 v147, 3, v1
  v_lshl_add_u32 v146, v147, 3, v146
  s_lshl_b32 s70, s60, 5
  s_add_u32 s70, s70, 139264
  v_add_u32 v146, s70, v146
  s_waitcnt vmcnt(6)
  v_lshlrev_b32 v108, 16, v250
  v_and_b32 v109, 0xffff0000, v250
  v_mul_f32 v110, 0xbfb8aa3b, v108
  v_mul_f32 v111, 0xbfb8aa3b, v109
  v_exp_f32 v110, v110
  v_exp_f32 v111, v111
  v_mov_b32 v148, 0x07060501
  v_add_f32 v110, 1.0, v110
  v_add_f32 v111, 1.0, v111
  v_rcp_f32 v110, v110
  v_rcp_f32 v111, v111
  v_mov_b32 v149, 0x07060502
  v_mul_f32 v110, v110, v108
  v_mul_f32 v111, v111, v109
  v_cvt_pk_bf16_f32 v104, v110, v111
  v_mov_b32 v150, 0x07060503
  ds_write_b32 v144, v104
  ds_read_b128 v[112:115], v145 offset:0
  ds_read_b128 v[116:119], v145 offset:64
  ds_read_b128 v[120:123], v145 offset:128
  ds_read_b128 v[124:127], v145 offset:192
C_3:
  s_cmp_gt_u32 s60, 1
  s_cbranch_scc1 C_4
  s_mov_b32 s70, 0x3f803f80
  s_lshl_b32 s72, s58, 11
  s_lshl_b32 s73, s59, 7
  s_add_u32 s72, s72, s73
  s_lshl_b32 s73, s60, 6
  s_add_u32 s72, s72, s73
  s_add_u32 s72, s72, 4096
  s_cmp_lt_u32 s52, 8
  s_cbranch_scc1 C_5
  s_waitcnt vmcnt(2)
C_5:
  v_dot2_f32_bf16 v224, v208, s70, 0
  v_dot2_f32_bf16 v226, v208, v208, 0
  v_dot2_f32_bf16 v225, v209, s70, 0
  v_dot2_f32_bf16 v227, v209, v209, 0
  v_dot2_f32_bf16 v224, v210, s70, v224
  v_dot2_f32_bf16 v226, v210, v210, v226
  v_dot2_f32_bf16 v225, v211, s70, v225
  v_dot2_f32_bf16 v227, v211, v211, v227
  v_dot2_f32_bf16 v224, v212, s70, v224
  v_dot2_f32_bf16 v226, v212, v212, v226
  v_dot2_f32_bf16 v225, v213, s70, v225
  v_dot2_f32_bf16 v227, v213, v213, v227
  v_dot2_f32_bf16 v224, v214, s70, v224
  v_dot2_f32_bf16 v226, v214, v214, v226
  v_dot2_f32_bf16 v225, v215, s70, v225
  v_dot2_f32_bf16 v227, v215, v215, v227
  v_dot2_f32_bf16 v224, v216, s70, v224
  v_dot2_f32_bf16 v226, v216, v216, v226
  v_dot2_f32_bf16 v225, v217, s70, v225
  v_dot2_f32_bf16 v227, v217, v217, v227
  v_dot2_f32_bf16 v224, v218, s70, v224
  v_dot2_f32_bf16 v226, v218, v218, v226
  v_dot2_f32_bf16 v225, v219, s70, v225
  v_dot2_f32_bf16 v227, v219, v219, v227
  v_dot2_f32_bf16 v224, v220, s70, v224
  v_dot2_f32_bf16 v226, v220, v220, v226
  v_dot2_f32_bf16 v225, v221, s70, v225
  v_dot2_f32_bf16 v227, v221, v221, v227
  v_dot2_f32_bf16 v224, v222, s70, v224
  v_dot2_f32_bf16 v226, v222, v222, v226
  v_dot2_f32_bf16 v225, v223, s70, v225
  v_dot2_f32_bf16 v227, v223, v223, v227
  v_mov_b32 v228, 0x3727c5ac
  s_nop 0
  v_add_f32 v224, v224, v225
  v_add_f32 v225, v226, v227
  s_nop 0
  v_add_f32_dpp v224, v224, v224 row_ror:1 row_mask:0xf bank_mask:0xf
  v_add_f32_dpp v225, v225, v225 row_ror:1 row_mask:0xf bank_mask:0xf
  s_nop 0
  v_add_f32_dpp v224, v224, v224 row_ror:2 row_mask:0xf bank_mask:0xf
  v_add_f32_dpp v225, v225, v225 row_ror:2 row_mask:0xf bank_mask:0xf
  s_nop 0
  v_add_f32_dpp v224, v224, v224 row_ror:4 row_mask:0xf bank_mask:0xf
  v_add_f32_dpp v225, v225, v225 row_ror:4 row_mask:0xf bank_mask:0xf
  s_nop 0
  v_add_f32_dpp v224, v224, v224 row_ror:8 row_mask:0xf bank_mask:0xf
  v_add_f32_dpp v225, v225, v225 row_ror:8 row_mask:0xf bank_mask:0xf
  s_waitcnt lgkmcnt(0)
  s_mul_i32 s56, s56, 0x9E3779B5
  s_add_u32 s56, s56, 0x7F4A7C15
  v_mov_b32 v226, s61
  v_mov_b32 v227, s56
  v_mul_f32 v224, 0.001953125, v224
  v_fmac_f32 v228, 0.001953125, v225
  v_fma_f32 v225, -v224, v224, v228
  v_max_f32 v225, 0x3727c5ac, v225
  v_rsq_f32 v225, v225
  s_mov_b32 exec_lo, 0x00010001
  s_mov_b32 exec_hi, 0x00010001
  v_mul_f32 v224, v224, v225
  buffer_store_dwordx4 v[224:227], v1, s[48:51], s72 offen sc1
  s_mov_b64 exec, -1
C_4:
  s_cmp_ge_u32 s52, 8
  s_cbranch_scc1 C_6
  s_cmp_gt_u32 s60, 1
  s_cbranch_scc0 C_7
  s_waitcnt vmcnt(2)
  s_waitcnt lgkmcnt(0)
  s_mul_i32 s56, s56, 0x9E3779B5
  s_add_u32 s56, s56, 0x7F4A7C15
C_7:
  s_waitcnt vmcnt(3) lgkmcnt(0)
  s_barrier
  ds_read_b64_tr_b16 v[128:129], v146 offset:0
  ds_read_b64_tr_b16 v[130:131], v146 offset:512
  ds_read_b64_tr_b16 v[132:133], v146 offset:4096
  ds_read_b64_tr_b16 v[134:135], v146 offset:4608
  ds_read_b64_tr_b16 v[136:137], v146 offset:8192
  ds_read_b64_tr_b16 v[138:139], v146 offset:8704
  ds_read_b64_tr_b16 v[140:141], v146 offset:12288
  ds_read_b64_tr_b16 v[142:143], v146 offset:12800
  v_mov_b32 v107, s56
  s_waitcnt lgkmcnt(6)
  v_mfma_f32_16x16x32_bf16 v[96:99], v[128:131], v[112:115], 0
  s_waitcnt lgkmcnt(4)
  v_mfma_f32_16x16x32_bf16 v[96:99], v[132:135], v[116:119], v[96:99]
  s_waitcnt lgkmcnt(2)
  v_mfma_f32_16x16x32_bf16 v[96:99], v[136:139], v[120:123], v[96:99]
  s_waitcnt lgkmcnt(0)
  v_mfma_f32_16x16x32_bf16 v[96:99], v[140:143], v[124:127], v[96:99]
  s_mov_b32 exec_lo, 0x00010001
  s_mov_b32 exec_hi, 0x00010001
  s_nop 5
  v_perm_b32 v104, v96, v99, v148
  v_perm_b32 v105, v97, v99, v149
  v_perm_b32 v106, v98, v99, v150
  buffer_store_dwordx4 v[104:107], v1, s[48:51], s98 offen sc1
  s_mov_b64 exec, -1
C_6:
  s_cmp_lt_u32 s52, 8
  s_cbranch_scc1 C_8
  s_cmp_gt_u32 s60, 1
  s_cbranch_scc1 C_9
  s_barrier
C_9:
C_8:
  s_cmp_gt_u32 s60, 1
  s_cbranch_scc0 L_pj
  s_cmp_lt_u32 s52, 8
  s_cbranch_scc1 C_10
  s_lshl1_add_u32 s55, s52, s60
  s_and_b32 s3, s2, 7
  s_mul_i32 s3, s3, 6
  s_add_u32 s3, s3, s55
  s_sub_u32 s3, s3, 18
  s_sub_u32 s55, s3, 48
  s_cmp_ge_u32 s3, 48
  s_cselect_b32 s3, s55, s3
  s_mul_i32 s3, s3, 33792
  v_lshrrev_b32 v246, 4, v1
  v_and_b32 v247, 15, v1
  v_mul_u32_u24 v246, 3072, v246
  v_lshl_add_u32 v246, v247, 7, v246
  s_barrier
  buffer_load_dword v255, v246, s[12:15], s3 offen offset:1024
  s_add_u32 s3, s3, 12288
  buffer_load_dword v255, v246, s[12:15], s3 offen offset:1024
  s_add_u32 s3, s3, 12288
  buffer_load_dword v255, v246, s[12:15], s3 offen offset:1024
C_10:
  s_xor_b32 m0, s71, 0
  s_nop 0
  buffer_load_dwordx4 v12, s[12:15], s66 offen lds
  s_xor_b32 m0, s71, 8192
  s_nop 0
  buffer_load_dwordx4 v16, s[12:15], s66 offen lds
  s_xor_b32 m0, s71, 1024
  s_nop 0
  buffer_load_dwordx4 v15, s[12:15], s66 offen lds
  s_xor_b32 m0, s71, 9216
  s_nop 0
  buffer_load_dwordx4 v17, s[12:15], s66 offen lds
  s_xor_b32 m0, s71, 2048
  s_nop 0
  buffer_load_dwordx4 v12, s[12:15], s67 offen lds
  s_xor_b32 m0, s71, 10240
  s_nop 0
  buffer_load_dwordx4 v16, s[12:15], s67 offen lds
  s_xor_b32 m0, s71, 3072
  s_nop 0
  buffer_load_dwordx4 v15, s[12:15], s67 offen lds
  s_xor_b32 m0, s71, 11264
  s_nop 0
  buffer_load_dwordx4 v17, s[12:15], s67 offen lds
  s_xor_b32 m0, s71, 4096
  s_nop 0
  buffer_load_dwordx4 v12, s[12:15], s68 offen lds
  s_xor_b32 m0, s71, 12288
  s_nop 0
  buffer_load_dwordx4 v16, s[12:15], s68 offen lds
  s_xor_b32 m0, s71, 5120
  s_nop 0
  buffer_load_dwordx4 v15, s[12:15], s68 offen lds
  s_xor_b32 m0, s71, 13312
  s_nop 0
  buffer_load_dwordx4 v17, s[12:15], s68 offen lds
  s_cmp_lt_u32 s52, 8
  s_cbranch_scc1 C_11
  s_sub_u32 s3, s3, 24576
  v_mul_u32_u24 v247, 3072, v7
  v_lshl_add_u32 v247, v9, 7, v247
  buffer_load_dword v255, v247, s[12:15], s3 offen
  s_add_u32 s3, s3, 24576
  s_mov_b32 exec_hi, 0
  buffer_load_dword v255, v247, s[12:15], s3 offen
  s_mov_b32 exec_hi, -1
C_11:
  s_cmp_lt_u32 s52, 8
  s_cbranch_scc1 C_12
  s_waitcnt lgkmcnt(0)
  s_mul_i32 s56, s56, 0x9E3779B5
  s_add_u32 s56, s56, 0x7F4A7C15
C_12:
  s_cmp_lg_u32 s60, 2
  s_cbranch_scc1 C_13
  v_mov_b32 v20, 0
  v_and_b32 v21, 63, v253
  v_add_u32 v21, 114048, v21
  ds_write_b32 v21, v20
  s_lshl_b32 s72, s59, 10
  s_mov_b32 m0, 106496
  v_lshlrev_b32 v20, 7, v1
  buffer_load_dwordx4 v2, s[16:19], s72 offen lds
  s_mov_b64 exec, 0x7ff
  buffer_load_dword v255, v20, s[48:51], s62 offen sc1
  s_mov_b64 exec, -1
C_13:
L_pj:
  s_lshl_b32 s63, s58, 17
  s_add_u32 s63, s63, 2097152
  s_mul_i32 s64, s58, 352256
  s_add_u32 s64, s64, 4194304
  s_mov_b32 s80, 0x3fb8aa3b
  s_mov_b32 s81, 0x3fb8aa3b
  s_and_b32 s74, s60, 1
  s_lshr_b32 s75, s60, 1
  s_lshr_b32 s76, s59, 3
  s_lshl_b32 s76, s76, 1
  s_add_u32 s76, s76, s74
  s_and_b32 s77, s59, 7
  s_lshl_b32 s77, s77, 1
  s_add_u32 s77, s77, s75
  s_sub_u32 s99, s52, 8
  s_cmp_ge_u32 s99, 16
  s_cselect_b32 s66, 0x40000000, 0
  v_add_u32 v252, s66, v252
  v_bfe_u32 v13, v1, 2, 3
  v_lshlrev_b32 v13, 10, v13
  v_lshl_add_u32 v13, v3, 6, v13
  v_lshl_add_u32 v13, v4, 4, v13
  v_lshlrev_b32 v19, 3, v1
  s_lshl_b32 s91, s60, 15
  s_add_u32 s91, s91, s63
  s_add_u32 s92, s91, 16384
  s_lshr_b32 s66, s52, 3
  s_and_b32 s67, s66, 1
  s_lshr_b32 s66, s66, 1
  s_lshl_b32 s68, s67, 12
  s_lshl_b32 s69, s66, 15
  s_or_b32 s68, s68, s69
  s_lshl_b32 s88, s60, 13
  s_or_b32 s88, s88, s68
  s_and_b32 s68, s2, 3
  s_lshl_b32 s68, s68, 10
  s_or_b32 s88, s88, s68
  s_lshl_b32 s87, s88, 3
  s_and_b32 s68, s59, 7
  s_lshl_b32 s68, s68, 7
  s_or_b32 s87, s87, s68
  s_lshl_b32 s93, s60, 15
  s_or_b32 s93, s93, s68
  s_and_b32 s67, s2, 7
  s_lshl2_add_u32 s90, s66, s67
  s_mul_i32 s69, s59, 192
  s_min_u32 s69, s69, 2560
  s_mul_i32 s89, s60, 44032
  s_add_u32 s89, s89, s69
  s_cmp_eq_u32 s59, 15
  s_cselect_b32 s66, 0x40000000, 0
  v_mul_u32_u24 v244, 2752, v6
  v_add_u32 v244, s66, v244
  v_xor_b32 v245, 2, v4
  v_lshl_add_u32 v245, v245, 4, v244
  v_lshl_add_u32 v244, v4, 4, v244
  v_and_b32 v20, 31, v1
  s_lshl_b32 s66, s60, 8
  s_add_u32 s66, s66, 109056
  v_lshl_add_u32 v20, v20, 3, s66
  v_lshlrev_b32 v21, 5, v3
  v_add_u32 v21, 108800, v21
  v_mov_b32 v22, 110080
  s_lshr_b32 s66, s52, 3
  s_lshl2_add_u32 s66, s66, s60
  s_mul_i32 s66, s66, 88064
  s_and_b32 s67, s59, 7
  s_lshl_b32 s67, s67, 7
  s_add_u32 s66, s66, s67
  v_lshl_add_u32 v254, v6, 10, s66
  s_and_b32 s67, s2, 7
  s_sub_u32 s66, s67, 6
  s_cmp_ge_u32 s67, 6
  s_cselect_b32 s67, s66, s67
  s_lshl_b32 s95, s67, 14
  v_lshlrev_b32 v23, 7, v6
  s_lshl2_add_u32 s66, s59, s60
  s_mul_i32 s66, s66, 2752
  v_min_u32 v246, 21, v1
  v_lshl_add_u32 v246, v246, 7, s66
  s_lshl2_add_u32 s66, s52, s60
  s_and_b32 s67, s2, 7
  s_lshl4_add_u32 s66, s67, s66
  s_and_b32 s66, s66, 127
  s_lshl_b32 s66, s66, 12
  v_and_b32 v247, 31, v1
  v_lshl_add_u32 v247, v247, 7, s66
  s_mul_i32 s66, s66, 3
  v_bfe_u32 v248, v1, 3, 2
  v_mul_u32_u24 v248, 3072, v248
  v_lshl_add_u32 v248, v9, 7, v248
  v_add_u32 v248, s66, v248
  s_cmp_gt_u32 s60, 1
  s_cbranch_scc1 L_15
  s_cmp_eq_u32 s60, 1
  s_cbranch_scc1 L_14
  v_lshrrev_b32 v7, 4, v1
  v_mul_u32_u24 v8, 12288, v7
  v_bfe_u32 v10, v1, 3, 1
  v_lshl_add_u32 v8, v10, 11, v8
  v_lshl_add_u32 v8, v9, 4, v8
  v_cvt_f32_u32 v10, v10
  v_and_b32 v16, 15, v1
  v_lshlrev_b32 v16, 4, v16
  v_lshl_add_u32 v16, v7, 2, v16
  v_add_u32 v16, 108800, v16
  s_lshl_b32 s66, s59, 7
  s_add_u32 s66, s66, 606208
  s_mov_b32 s65, 0
P_16:
  buffer_load_dwordx4 v[208:211], v8, s[48:51], s66 offen sc1
  s_add_u32 s65, s65, 1
  s_cmp_gt_u32 s65, 20000
  s_cbranch_scc1 PE_17
  s_waitcnt vmcnt(0)
  v_cmp_ne_u32 vcc, s56, v211
  s_cbranch_vccnz P_16
PE_17:
  s_waitcnt vmcnt(0)
  s_mov_b32 s70, 0x0c0c0400
  s_mov_b32 s71, 0x0401000c
  v_perm_b32 v211, v209, v208, s70
  v_perm_b32 v211, v210, v211, s71
  v_permlane32_swap_b32 v208, v210
  s_nop 0
  v_permlane32_swap_b32 v209, v211
  v_add_f32 v208, v208, v210
  v_add_f32 v209, v209, v211
  s_nop 1
  v_permlane16_swap_b32 v208, v209
  v_add_f32 v208, v208, v209
  v_cvt_pk_bf16_f32 v208, v208, v208
  v_and_b32 v208, 0xffff0000, v208
  v_add_f32 v208, v10, v208
  v_cvt_pk_bf16_f32 v208, v208, v208
  v_and_b32 v208, 0xffff0000, v208
  ds_write_b32 v16, v208
  s_branch L_15
L_14:
  s_lshl_b32 s72, s58, 11
  s_add_u32 s72, s72, 4096
  v_add_u32 v19, 109056, v19
  s_mov_b32 s65, 0
P_18:
  buffer_load_dwordx4 v[208:211], v2, s[48:51], s72 offen sc1
  buffer_load_dwordx4 v[212:215], v2, s[48:51], s72 offen offset:1024 sc1
  s_add_u32 s65, s65, 1
  s_cmp_gt_u32 s65, 20000
  s_cbranch_scc1 PE_19
  s_waitcnt vmcnt(0)
  v_min_u32 v216, v211, v215
  v_max_u32 v217, v211, v215
  v_xor_b32 v216, s56, v216
  v_xor_b32 v217, s56, v217
  v_or_b32 v216, v216, v217
  v_cmp_ne_u32 vcc, 0, v216
  s_cbranch_vccnz P_18
PE_19:
  s_waitcnt vmcnt(0)
  ds_write_b64 v19, v[208:209]
  ds_write_b64 v19, v[212:213] offset:512
  v_cmp_ne_u32 vcc, s61, v210
  v_cmp_ne_u32 s[6:7], s61, v214
  s_nop 0
  s_or_b64 vcc, vcc, s[6:7]
  s_cselect_b32 s66, 0, 1
  v_mov_b32 v208, s66
  ds_write_b32 v22, v208
L_15:
  s_waitcnt vmcnt(12)
  v_lshlrev_b32 v192, 16, v184
  v_and_b32 v193, 0xffff0000, v184
  v_lshlrev_b32 v194, 16, v185
  v_and_b32 v195, 0xffff0000, v185
  v_lshlrev_b32 v196, 16, v186
  v_and_b32 v197, 0xffff0000, v186
  v_lshlrev_b32 v198, 16, v187
  v_and_b32 v199, 0xffff0000, v187
  v_lshlrev_b32 v200, 16, v188
  v_and_b32 v201, 0xffff0000, v188
  v_lshlrev_b32 v202, 16, v189
  v_and_b32 v203, 0xffff0000, v189
  v_lshlrev_b32 v204, 16, v190
  v_and_b32 v205, 0xffff0000, v190
  v_lshlrev_b32 v206, 16, v191
  v_and_b32 v207, 0xffff0000, v191
  s_waitcnt lgkmcnt(0)
  s_barrier
  ds_read_b64 v[208:209], v20
  ds_read_b32 v210, v22
  ds_read_b128 v[212:215], v21 offset:0
  ds_read_b128 v[216:219], v21 offset:16
  ds_read_b128 v[220:223], v21 offset:64
  ds_read_b128 v[224:227], v21 offset:80
  ds_read_b128 v[228:231], v21 offset:128
  ds_read_b128 v[232:235], v21 offset:144
  ds_read_b128 v[236:239], v21 offset:192
  ds_read_b128 v[240:243], v21 offset:208
  s_lshl_b32 s72, s59, 11
  s_add_u32 s72, s72, s91
  s_lshl_b32 s71, s60, 6
  s_add_u32 s71, s71, s62
  s_lshl_b32 s73, s59, 2
  s_add_u32 s73, s73, s71
  s_waitcnt lgkmcnt(8)
  v_readfirstlane_b32 s57, v210
  v_pk_fma_f32 v[192:193], v[192:193], v[208:209], v[208:209] op_sel:[0,1,0] op_sel_hi:[1,1,0] neg_lo:[0,0,1] neg_hi:[0,0,1]
  v_pk_fma_f32 v[194:195], v[194:195], v[208:209], v[208:209] op_sel:[0,1,0] op_sel_hi:[1,1,0] neg_lo:[0,0,1] neg_hi:[0,0,1]
  v_pk_fma_f32 v[196:197], v[196:197], v[208:209], v[208:209] op_sel:[0,1,0] op_sel_hi:[1,1,0] neg_lo:[0,0,1] neg_hi:[0,0,1]
  v_pk_fma_f32 v[198:199], v[198:199], v[208:209], v[208:209] op_sel:[0,1,0] op_sel_hi:[1,1,0] neg_lo:[0,0,1] neg_hi:[0,0,1]
  v_pk_fma_f32 v[200:201], v[200:201], v[208:209], v[208:209] op_sel:[0,1,0] op_sel_hi:[1,1,0] neg_lo:[0,0,1] neg_hi:[0,0,1]
  v_pk_fma_f32 v[202:203], v[202:203], v[208:209], v[208:209] op_sel:[0,1,0] op_sel_hi:[1,1,0] neg_lo:[0,0,1] neg_hi:[0,0,1]
  v_pk_fma_f32 v[204:205], v[204:205], v[208:209], v[208:209] op_sel:[0,1,0] op_sel_hi:[1,1,0] neg_lo:[0,0,1] neg_hi:[0,0,1]
  v_pk_fma_f32 v[206:207], v[206:207], v[208:209], v[208:209] op_sel:[0,1,0] op_sel_hi:[1,1,0] neg_lo:[0,0,1] neg_hi:[0,0,1]
  s_waitcnt lgkmcnt(0)
  v_pk_fma_f32 v[192:193], v[192:193], v[228:229], v[212:213]
  v_pk_fma_f32 v[194:195], v[194:195], v[230:231], v[214:215]
  v_pk_fma_f32 v[196:197], v[196:197], v[232:233], v[216:217]
  v_pk_fma_f32 v[198:199], v[198:199], v[234:235], v[218:219]
  v_pk_fma_f32 v[200:201], v[200:201], v[236:237], v[220:221]
  v_pk_fma_f32 v[202:203], v[202:203], v[238:239], v[222:223]
  v_pk_fma_f32 v[204:205], v[204:205], v[240:241], v[224:225]
  v_pk_fma_f32 v[206:207], v[206:207], v[242:243], v[226:227]
  v_cvt_pk_bf16_f32 v176, v192, v193
  v_cvt_pk_bf16_f32 v177, v194, v195
  v_cvt_pk_bf16_f32 v178, v196, v197
  v_cvt_pk_bf16_f32 v179, v198, v199
  v_cvt_pk_bf16_f32 v180, v200, v201
  v_cvt_pk_bf16_f32 v181, v202, v203
  v_cvt_pk_bf16_f32 v182, v204, v205
  v_cvt_pk_bf16_f32 v183, v206, v207
  buffer_store_dwordx4 v[176:179], v2, s[48:51], s72 offen sc1
  buffer_store_dwordx4 v[180:183], v2, s[48:51], s72 offen offset:1024 sc1
  v_bfe_u32 v7, v1, 4, 1
  v_lshl_add_u32 v7, v7, 2, v4
  v_and_b32 v8, 1, v7
  v_lshrrev_b32 v9, 1, v7
  v_bfe_u32 v10, v1, 2, 2
  v_lshlrev_b32 v16, 9, v8
  v_lshl_add_u32 v16, v10, 5, v16
  v_lshl_add_u32 v16, v9, 3, v16
  v_add_u32 v16, 106496, v16
  v_lshl_add_u32 v14, v3, 3, v10
  v_lshlrev_b32 v14, 6, v14
  v_lshl_add_u32 v14, v8, 5, v14
  v_lshl_add_u32 v14, v9, 3, v14
  v_bfe_u32 v8, v1, 2, 1
  v_cmp_eq_u32 s[4:5], v8, v3
  v_and_b32 v7, 15, v1
  v_lshlrev_b32 v7, 2, v7
  s_xor_b32 m0, s86, 6144
  s_add_u32 s55, s85, 1024
  buffer_load_dwordx4 v12, s[12:15], s55 offen lds
  s_xor_b32 m0, s86, 7168
  s_add_u32 s55, s85, 1024
  buffer_load_dwordx4 v15, s[12:15], s55 offen lds
  s_xor_b32 m0, s86, 32768
  s_add_u32 s55, s82, 2048
  buffer_load_dwordx4 v12, s[12:15], s55 offen lds
  s_xor_b32 m0, s86, 33792
  s_add_u32 s55, s82, 2048
  buffer_load_dwordx4 v15, s[12:15], s55 offen lds
  s_xor_b32 m0, s86, 34816
  s_add_u32 s55, s83, 2048
  buffer_load_dwordx4 v12, s[12:15], s55 offen lds
  s_xor_b32 m0, s86, 66560
  s_nop 0
  buffer_load_dwordx4 v15, s[12:15], s82 offen lds
  v_mov_b32 v3, 0
  v_mov_b32 v4, s56
  s_waitcnt vmcnt(6)
  s_mov_b64 exec, 1
  s_cmp_eq_u32 s57, 0
  s_cbranch_scc1 L_20
  buffer_store_dword v4, v3, s[48:51], s73 offen offset:0
  s_branch L_21
L_20:
  buffer_store_dword v4, v3, s[48:51], s73 offen offset:0 sc1
L_21:
  s_mov_b64 exec, -1
  buffer_load_dword v255, v23, s[48:51], s72 offen sc1
  s_xor_b32 m0, s86, 35840
  s_add_u32 s55, s83, 2048
  buffer_load_dwordx4 v15, s[12:15], s55 offen lds
  s_xor_b32 m0, s86, 36864
  s_add_u32 s55, s84, 2048
  buffer_load_dwordx4 v12, s[12:15], s55 offen lds
  s_xor_b32 m0, s86, 37888
  s_add_u32 s55, s84, 2048
  buffer_load_dwordx4 v15, s[12:15], s55 offen lds
  s_xor_b32 m0, s86, 38912
  s_add_u32 s55, s85, 2048
  buffer_load_dwordx4 v12, s[12:15], s55 offen lds
  s_xor_b32 m0, s86, 39936
  s_add_u32 s55, s85, 2048
  buffer_load_dwordx4 v15, s[12:15], s55 offen lds
  s_mov_b32 s65, 0
P_22:
  buffer_load_dword v4, v7, s[48:51], s71 offen offset:0 sc1
  s_add_u32 s65, s65, 1
  s_cmp_gt_u32 s65, 20000
  s_cbranch_scc1 PE_23
  s_waitcnt vmcnt(0)
  v_cmp_ne_u32 vcc, s56, v4
  s_cbranch_vccnz P_22
PE_23:
  s_waitcnt vmcnt(0)
  s_add_u32 s55, s91, 0
  buffer_load_dwordx4 a[0:3], v2, s[48:51], s55 offen offset:0 sc1
  s_add_u32 s55, s91, 0
  buffer_load_dwordx4 a[4:7], v2, s[48:51], s55 offen offset:1024 sc1
  s_add_u32 s55, s91, 0
  buffer_load_dwordx4 a[8:11], v2, s[48:51], s55 offen offset:2048 sc1
  s_add_u32 s55, s91, 0
  buffer_load_dwordx4 a[12:15], v2, s[48:51], s55 offen offset:3072 sc1
  s_add_u32 s55, s91, 4096
  buffer_load_dwordx4 a[16:19], v2, s[48:51], s55 offen offset:0 sc1
  s_add_u32 s55, s91, 4096
  buffer_load_dwordx4 a[20:23], v2, s[48:51], s55 offen offset:1024 sc1
  s_add_u32 s55, s91, 4096
  buffer_load_dwordx4 a[24:27], v2, s[48:51], s55 offen offset:2048 sc1
  s_add_u32 s55, s91, 4096
  buffer_load_dwordx4 a[28:31], v2, s[48:51], s55 offen offset:3072 sc1
  s_barrier
  ds_read_b64_tr_b16 v[24:25], v16 offset:0
  ds_read_b64_tr_b16 v[26:27], v16 offset:128
  ds_read_b64_tr_b16 v[28:29], v16 offset:256
  ds_read_b64_tr_b16 v[30:31], v16 offset:384
  s_waitcnt lgkmcnt(0)
  v_cndmask_b32 v24, 0, v24, s[4:5]
  v_cndmask_b32 v25, 0, v25, s[4:5]
  v_cndmask_b32 v26, 0, v26, s[4:5]
  v_cndmask_b32 v27, 0, v27, s[4:5]
  v_cndmask_b32 v28, 0, v28, s[4:5]
  v_cndmask_b32 v29, 0, v29, s[4:5]
  v_cndmask_b32 v30, 0, v30, s[4:5]
  v_cndmask_b32 v31, 0, v31, s[4:5]
  ds_read_b64_tr_b16 v[80:81], v14 offset:0
  ds_read_b64_tr_b16 v[82:83], v14 offset:256
  ds_read_b64_tr_b16 v[84:85], v14 offset:32768
  ds_read_b64_tr_b16 v[86:87], v14 offset:33024
  ds_read_b64_tr_b16 v[88:89], v14 offset:1024
  ds_read_b64_tr_b16 v[90:91], v14 offset:1280
  ds_read_b64_tr_b16 v[92:93], v14 offset:33792
  ds_read_b64_tr_b16 v[94:95], v14 offset:34048
  ds_read_b64_tr_b16 v[96:97], v14 offset:2048
  ds_read_b64_tr_b16 v[98:99], v14 offset:2304
  ds_read_b64_tr_b16 v[100:101], v14 offset:34816
  ds_read_b64_tr_b16 v[102:103], v14 offset:35072
  s_waitcnt vmcnt(7) lgkmcnt(8)
  v_mfma_f32_32x32x16_bf16 v[32:47], v[80:83], a[0:3], 0
  s_add_u32 s55, s91, 8192
  buffer_load_dwordx4 a[32:35], v2, s[48:51], s55 offen offset:0 sc1
  v_mfma_f32_32x32x16_bf16 v[48:63], v[84:87], a[0:3], 0
  ds_read_b64_tr_b16 v[80:81], v14 offset:3072
  ds_read_b64_tr_b16 v[82:83], v14 offset:3328
  ds_read_b64_tr_b16 v[84:85], v14 offset:35840
  ds_read_b64_tr_b16 v[86:87], v14 offset:36096
  s_waitcnt vmcnt(7) lgkmcnt(8)
  v_mfma_f32_32x32x16_bf16 v[32:47], v[88:91], a[4:7], v[32:47]
  s_add_u32 s55, s91, 8192
  buffer_load_dwordx4 a[36:39], v2, s[48:51], s55 offen offset:1024 sc1
  v_mfma_f32_32x32x16_bf16 v[48:63], v[92:95], a[4:7], v[48:63]
  ds_read_b64_tr_b16 v[88:89], v14 offset:4096
  ds_read_b64_tr_b16 v[90:91], v14 offset:4352
  ds_read_b64_tr_b16 v[92:93], v14 offset:36864
  ds_read_b64_tr_b16 v[94:95], v14 offset:37120
  s_waitcnt vmcnt(7) lgkmcnt(8)
  v_mfma_f32_32x32x16_bf16 v[32:47], v[96:99], a[8:11], v[32:47]
  s_add_u32 s55, s91, 8192
  buffer_load_dwordx4 a[40:43], v2, s[48:51], s55 offen offset:2048 sc1
  v_mfma_f32_32x32x16_bf16 v[48:63], v[100:103], a[8:11], v[48:63]
  ds_read_b64_tr_b16 v[96:97], v14 offset:5120
  ds_read_b64_tr_b16 v[98:99], v14 offset:5376
  ds_read_b64_tr_b16 v[100:101], v14 offset:37888
  ds_read_b64_tr_b16 v[102:103], v14 offset:38144
  s_waitcnt vmcnt(7) lgkmcnt(8)
  v_mfma_f32_32x32x16_bf16 v[32:47], v[80:83], a[12:15], v[32:47]
  s_add_u32 s55, s91, 8192
  buffer_load_dwordx4 a[44:47], v2, s[48:51], s55 offen offset:3072 sc1
  v_mfma_f32_32x32x16_bf16 v[48:63], v[84:87], a[12:15], v[48:63]
  ds_read_b64_tr_b16 v[80:81], v14 offset:6144
  ds_read_b64_tr_b16 v[82:83], v14 offset:6400
  ds_read_b64_tr_b16 v[84:85], v14 offset:38912
  ds_read_b64_tr_b16 v[86:87], v14 offset:39168
  s_waitcnt vmcnt(7) lgkmcnt(8)
  v_mfma_f32_32x32x16_bf16 v[32:47], v[88:91], a[16:19], v[32:47]
  s_add_u32 s55, s91, 12288
  buffer_load_dwordx4 a[48:51], v2, s[48:51], s55 offen offset:0 sc1
  v_mfma_f32_32x32x16_bf16 v[48:63], v[92:95], a[16:19], v[48:63]
  ds_read_b64_tr_b16 v[88:89], v14 offset:7168
  ds_read_b64_tr_b16 v[90:91], v14 offset:7424
  ds_read_b64_tr_b16 v[92:93], v14 offset:39936
  ds_read_b64_tr_b16 v[94:95], v14 offset:40192
  s_waitcnt vmcnt(7) lgkmcnt(8)
  v_mfma_f32_32x32x16_bf16 v[32:47], v[96:99], a[20:23], v[32:47]
  s_add_u32 s55, s91, 12288
  buffer_load_dwordx4 a[52:55], v2, s[48:51], s55 offen offset:1024 sc1
  v_mfma_f32_32x32x16_bf16 v[48:63], v[100:103], a[20:23], v[48:63]
  ds_read_b64_tr_b16 v[96:97], v14 offset:8192
  ds_read_b64_tr_b16 v[98:99], v14 offset:8448
  ds_read_b64_tr_b16 v[100:101], v14 offset:40960
  ds_read_b64_tr_b16 v[102:103], v14 offset:41216
  s_waitcnt vmcnt(7) lgkmcnt(8)
  v_mfma_f32_32x32x16_bf16 v[32:47], v[80:83], a[24:27], v[32:47]
  s_add_u32 s55, s91, 12288
  buffer_load_dwordx4 a[56:59], v2, s[48:51], s55 offen offset:2048 sc1
  v_mfma_f32_32x32x16_bf16 v[48:63], v[84:87], a[24:27], v[48:63]
  ds_read_b64_tr_b16 v[80:81], v14 offset:9216
  ds_read_b64_tr_b16 v[82:83], v14 offset:9472
  ds_read_b64_tr_b16 v[84:85], v14 offset:41984
  ds_read_b64_tr_b16 v[86:87], v14 offset:42240
  s_waitcnt vmcnt(7) lgkmcnt(8)
  v_mfma_f32_32x32x16_bf16 v[32:47], v[88:91], a[28:31], v[32:47]
  s_add_u32 s55, s91, 12288
  buffer_load_dwordx4 a[60:63], v2, s[48:51], s55 offen offset:3072 sc1
  v_mfma_f32_32x32x16_bf16 v[48:63], v[92:95], a[28:31], v[48:63]
  ds_read_b64_tr_b16 v[88:89], v14 offset:10240
  ds_read_b64_tr_b16 v[90:91], v14 offset:10496
  ds_read_b64_tr_b16 v[92:93], v14 offset:43008
  ds_read_b64_tr_b16 v[94:95], v14 offset:43264
  s_waitcnt vmcnt(7) lgkmcnt(8)
  v_mfma_f32_32x32x16_bf16 v[32:47], v[96:99], a[32:35], v[32:47]
  s_add_u32 s55, s92, 0
  buffer_load_dwordx4 a[64:67], v2, s[48:51], s55 offen offset:0 sc1
  v_mfma_f32_32x32x16_bf16 v[48:63], v[100:103], a[32:35], v[48:63]
  ds_read_b64_tr_b16 v[96:97], v14 offset:11264
  ds_read_b64_tr_b16 v[98:99], v14 offset:11520
  ds_read_b64_tr_b16 v[100:101], v14 offset:44032
  ds_read_b64_tr_b16 v[102:103], v14 offset:44288
  s_waitcnt vmcnt(7) lgkmcnt(8)
  v_mfma_f32_32x32x16_bf16 v[32:47], v[80:83], a[36:39], v[32:47]
  s_add_u32 s55, s92, 0
  buffer_load_dwordx4 a[68:71], v2, s[48:51], s55 offen offset:1024 sc1
  v_mfma_f32_32x32x16_bf16 v[48:63], v[84:87], a[36:39], v[48:63]
  ds_read_b64_tr_b16 v[80:81], v14 offset:12288
  ds_read_b64_tr_b16 v[82:83], v14 offset:12544
  ds_read_b64_tr_b16 v[84:85], v14 offset:45056
  ds_read_b64_tr_b16 v[86:87], v14 offset:45312
  s_waitcnt vmcnt(7) lgkmcnt(8)
  v_mfma_f32_32x32x16_bf16 v[32:47], v[88:91], a[40:43], v[32:47]
  s_add_u32 s55, s92, 0
  buffer_load_dwordx4 a[72:75], v2, s[48:51], s55 offen offset:2048 sc1
  v_mfma_f32_32x32x16_bf16 v[48:63], v[92:95], a[40:43], v[48:63]
  ds_read_b64_tr_b16 v[88:89], v14 offset:13312
  ds_read_b64_tr_b16 v[90:91], v14 offset:13568
  ds_read_b64_tr_b16 v[92:93], v14 offset:46080
  ds_read_b64_tr_b16 v[94:95], v14 offset:46336
  s_waitcnt vmcnt(7) lgkmcnt(8)
  v_mfma_f32_32x32x16_bf16 v[32:47], v[96:99], a[44:47], v[32:47]
  s_add_u32 s55, s92, 0
  buffer_load_dwordx4 a[76:79], v2, s[48:51], s55 offen offset:3072 sc1
  v_mfma_f32_32x32x16_bf16 v[48:63], v[100:103], a[44:47], v[48:63]
  ds_read_b64_tr_b16 v[96:97], v14 offset:14336
  ds_read_b64_tr_b16 v[98:99], v14 offset:14592
  ds_read_b64_tr_b16 v[100:101], v14 offset:47104
  ds_read_b64_tr_b16 v[102:103], v14 offset:47360
  s_waitcnt vmcnt(7) lgkmcnt(8)
  v_mfma_f32_32x32x16_bf16 v[32:47], v[80:83], a[48:51], v[32:47]
  s_add_u32 s55, s92, 4096
  buffer_load_dwordx4 a[80:83], v2, s[48:51], s55 offen offset:0 sc1
  v_mfma_f32_32x32x16_bf16 v[48:63], v[84:87], a[48:51], v[48:63]
  ds_read_b64_tr_b16 v[80:81], v14 offset:15360
  ds_read_b64_tr_b16 v[82:83], v14 offset:15616
  ds_read_b64_tr_b16 v[84:85], v14 offset:48128
  ds_read_b64_tr_b16 v[86:87], v14 offset:48384
  s_waitcnt vmcnt(7) lgkmcnt(8)
  v_mfma_f32_32x32x16_bf16 v[32:47], v[88:91], a[52:55], v[32:47]
  s_add_u32 s55, s92, 4096
  buffer_load_dwordx4 a[84:87], v2, s[48:51], s55 offen offset:1024 sc1
  v_mfma_f32_32x32x16_bf16 v[48:63], v[92:95], a[52:55], v[48:63]
  ds_read_b64_tr_b16 v[88:89], v14 offset:16384
  ds_read_b64_tr_b16 v[90:91], v14 offset:16640
  ds_read_b64_tr_b16 v[92:93], v14 offset:49152
  ds_read_b64_tr_b16 v[94:95], v14 offset:49408
  s_waitcnt vmcnt(7) lgkmcnt(8)
  v_mfma_f32_32x32x16_bf16 v[32:47], v[96:99], a[56:59], v[32:47]
  s_add_u32 s55, s92, 4096
  buffer_load_dwordx4 a[88:91], v2, s[48:51], s55 offen offset:2048 sc1
  v_mfma_f32_32x32x16_bf16 v[48:63], v[100:103], a[56:59], v[48:63]
  ds_read_b64_tr_b16 v[96:97], v14 offset:17408
  ds_read_b64_tr_b16 v[98:99], v14 offset:17664
  ds_read_b64_tr_b16 v[100:101], v14 offset:50176
  ds_read_b64_tr_b16 v[102:103], v14 offset:50432
  s_waitcnt vmcnt(7) lgkmcnt(8)
  v_mfma_f32_32x32x16_bf16 v[32:47], v[80:83], a[60:63], v[32:47]
  s_add_u32 s55, s92, 4096
  buffer_load_dwordx4 a[92:95], v2, s[48:51], s55 offen offset:3072 sc1
  v_mfma_f32_32x32x16_bf16 v[48:63], v[84:87], a[60:63], v[48:63]
  ds_read_b64_tr_b16 v[80:81], v14 offset:18432
  ds_read_b64_tr_b16 v[82:83], v14 offset:18688
  ds_read_b64_tr_b16 v[84:85], v14 offset:51200
  ds_read_b64_tr_b16 v[86:87], v14 offset:51456
  s_waitcnt vmcnt(7) lgkmcnt(8)
  v_mfma_f32_32x32x16_bf16 v[32:47], v[88:91], a[64:67], v[32:47]
  s_add_u32 s55, s92, 8192
  buffer_load_dwordx4 a[96:99], v2, s[48:51], s55 offen offset:0 sc1
  v_mfma_f32_32x32x16_bf16 v[48:63], v[92:95], a[64:67], v[48:63]
  ds_read_b64_tr_b16 v[88:89], v14 offset:19456
  ds_read_b64_tr_b16 v[90:91], v14 offset:19712
  ds_read_b64_tr_b16 v[92:93], v14 offset:52224
  ds_read_b64_tr_b16 v[94:95], v14 offset:52480
  s_waitcnt vmcnt(7) lgkmcnt(8)
  v_mfma_f32_32x32x16_bf16 v[32:47], v[96:99], a[68:71], v[32:47]
  s_add_u32 s55, s92, 8192
  buffer_load_dwordx4 a[100:103], v2, s[48:51], s55 offen offset:1024 sc1
  v_mfma_f32_32x32x16_bf16 v[48:63], v[100:103], a[68:71], v[48:63]
  ds_read_b64_tr_b16 v[96:97], v14 offset:20480
  ds_read_b64_tr_b16 v[98:99], v14 offset:20736
  ds_read_b64_tr_b16 v[100:101], v14 offset:53248
  ds_read_b64_tr_b16 v[102:103], v14 offset:53504
  s_waitcnt vmcnt(7) lgkmcnt(8)
  v_mfma_f32_32x32x16_bf16 v[32:47], v[80:83], a[72:75], v[32:47]
  s_add_u32 s55, s92, 8192
  buffer_load_dwordx4 a[104:107], v2, s[48:51], s55 offen offset:2048 sc1
  v_mfma_f32_32x32x16_bf16 v[48:63], v[84:87], a[72:75], v[48:63]
  ds_read_b64_tr_b16 v[80:81], v14 offset:21504
  ds_read_b64_tr_b16 v[82:83], v14 offset:21760
  ds_read_b64_tr_b16 v[84:85], v14 offset:54272
  ds_read_b64_tr_b16 v[86:87], v14 offset:54528
  s_waitcnt vmcnt(7) lgkmcnt(8)
  v_mfma_f32_32x32x16_bf16 v[32:47], v[88:91], a[76:79], v[32:47]
  s_add_u32 s55, s92, 8192
  buffer_load_dwordx4 a[108:111], v2, s[48:51], s55 offen offset:3072 sc1
  v_mfma_f32_32x32x16_bf16 v[48:63], v[92:95], a[76:79], v[48:63]
  ds_read_b64_tr_b16 v[88:89], v14 offset:22528
  ds_read_b64_tr_b16 v[90:91], v14 offset:22784
  ds_read_b64_tr_b16 v[92:93], v14 offset:55296
  ds_read_b64_tr_b16 v[94:95], v14 offset:55552
  s_waitcnt vmcnt(7) lgkmcnt(8)
  v_mfma_f32_32x32x16_bf16 v[32:47], v[96:99], a[80:83], v[32:47]
  s_add_u32 s55, s92, 12288
  buffer_load_dwordx4 a[112:115], v2, s[48:51], s55 offen offset:0 sc1
  v_mfma_f32_32x32x16_bf16 v[48:63], v[100:103], a[80:83], v[48:63]
  ds_read_b64_tr_b16 v[96:97], v14 offset:23552
  ds_read_b64_tr_b16 v[98:99], v14 offset:23808
  ds_read_b64_tr_b16 v[100:101], v14 offset:56320
  ds_read_b64_tr_b16 v[102:103], v14 offset:56576
  s_waitcnt vmcnt(7) lgkmcnt(8)
  v_mfma_f32_32x32x16_bf16 v[32:47], v[80:83], a[84:87], v[32:47]
  s_add_u32 s55, s92, 12288
  buffer_load_dwordx4 a[116:119], v2, s[48:51], s55 offen offset:1024 sc1
  v_mfma_f32_32x32x16_bf16 v[48:63], v[84:87], a[84:87], v[48:63]
  ds_read_b64_tr_b16 v[80:81], v14 offset:24576
  ds_read_b64_tr_b16 v[82:83], v14 offset:24832
  ds_read_b64_tr_b16 v[84:85], v14 offset:57344
  ds_read_b64_tr_b16 v[86:87], v14 offset:57600
  s_waitcnt vmcnt(7) lgkmcnt(8)
  v_mfma_f32_32x32x16_bf16 v[32:47], v[88:91], a[88:91], v[32:47]
  s_add_u32 s55, s92, 12288
  buffer_load_dwordx4 a[120:123], v2, s[48:51], s55 offen offset:2048 sc1
  s_xor_b32 m0, s86, 65536
  s_nop 0
  buffer_load_dwordx4 v12, s[12:15], s82 offen lds
  v_mfma_f32_32x32x16_bf16 v[48:63], v[92:95], a[88:91], v[48:63]
  ds_read_b64_tr_b16 v[88:89], v14 offset:25600
  ds_read_b64_tr_b16 v[90:91], v14 offset:25856
  ds_read_b64_tr_b16 v[92:93], v14 offset:58368
  ds_read_b64_tr_b16 v[94:95], v14 offset:58624
  s_waitcnt vmcnt(8) lgkmcnt(8)
  v_mfma_f32_32x32x16_bf16 v[32:47], v[96:99], a[92:95], v[32:47]
  s_add_u32 s55, s92, 12288
  buffer_load_dwordx4 a[124:127], v2, s[48:51], s55 offen offset:3072 sc1
  v_mfma_f32_32x32x16_bf16 v[48:63], v[100:103], a[92:95], v[48:63]
  ds_read_b64_tr_b16 v[96:97], v14 offset:26624
  ds_read_b64_tr_b16 v[98:99], v14 offset:26880
  ds_read_b64_tr_b16 v[100:101], v14 offset:59392
  ds_read_b64_tr_b16 v[102:103], v14 offset:59648
  s_waitcnt vmcnt(8) lgkmcnt(8)
  v_mfma_f32_32x32x16_bf16 v[32:47], v[80:83], a[96:99], v[32:47]
  s_xor_b32 m0, s86, 67584
  s_nop 0
  buffer_load_dwordx4 v12, s[12:15], s83 offen lds
  v_mfma_f32_32x32x16_bf16 v[48:63], v[84:87], a[96:99], v[48:63]
  ds_read_b64_tr_b16 v[80:81], v14 offset:27648
  ds_read_b64_tr_b16 v[82:83], v14 offset:27904
  ds_read_b64_tr_b16 v[84:85], v14 offset:60416
  ds_read_b64_tr_b16 v[86:87], v14 offset:60672
  s_waitcnt vmcnt(8) lgkmcnt(8)
  v_mfma_f32_32x32x16_bf16 v[32:47], v[88:91], a[100:103], v[32:47]
  s_xor_b32 m0, s86, 68608
  s_nop 0
  buffer_load_dwordx4 v15, s[12:15], s83 offen lds
  v_mfma_f32_32x32x16_bf16 v[48:63], v[92:95], a[100:103], v[48:63]
  ds_read_b64_tr_b16 v[88:89], v14 offset:28672
  ds_read_b64_tr_b16 v[90:91], v14 offset:28928
  ds_read_b64_tr_b16 v[92:93], v14 offset:61440
  ds_read_b64_tr_b16 v[94:95], v14 offset:61696
  s_waitcnt vmcnt(8) lgkmcnt(8)
  v_mfma_f32_32x32x16_bf16 v[32:47], v[96:99], a[104:107], v[32:47]
  s_xor_b32 m0, s86, 69632
  s_nop 0
  buffer_load_dwordx4 v12, s[12:15], s84 offen lds
  v_mfma_f32_32x32x16_bf16 v[48:63], v[100:103], a[104:107], v[48:63]
  ds_read_b64_tr_b16 v[96:97], v14 offset:29696
  ds_read_b64_tr_b16 v[98:99], v14 offset:29952
  ds_read_b64_tr_b16 v[100:101], v14 offset:62464
  ds_read_b64_tr_b16 v[102:103], v14 offset:62720
  s_waitcnt vmcnt(8) lgkmcnt(8)
  v_mfma_f32_32x32x16_bf16 v[32:47], v[80:83], a[108:111], v[32:47]
  s_xor_b32 m0, s86, 70656
  s_nop 0
  buffer_load_dwordx4 v15, s[12:15], s84 offen lds
  v_mfma_f32_32x32x16_bf16 v[48:63], v[84:87], a[108:111], v[48:63]
  ds_read_b64_tr_b16 v[80:81], v14 offset:30720
  ds_read_b64_tr_b16 v[82:83], v14 offset:30976
  ds_read_b64_tr_b16 v[84:85], v14 offset:63488
  ds_read_b64_tr_b16 v[86:87], v14 offset:63744
  s_waitcnt vmcnt(8) lgkmcnt(8)
  v_mfma_f32_32x32x16_bf16 v[32:47], v[88:91], a[112:115], v[32:47]
  s_xor_b32 m0, s86, 71680
  s_nop 0
  buffer_load_dwordx4 v12, s[12:15], s85 offen lds
  v_mfma_f32_32x32x16_bf16 v[48:63], v[92:95], a[112:115], v[48:63]
  ds_read_b64_tr_b16 v[88:89], v14 offset:31744
  ds_read_b64_tr_b16 v[90:91], v14 offset:32000
  ds_read_b64_tr_b16 v[92:93], v14 offset:64512
  ds_read_b64_tr_b16 v[94:95], v14 offset:64768
  s_waitcnt vmcnt(8) lgkmcnt(8)
  v_mfma_f32_32x32x16_bf16 v[32:47], v[96:99], a[116:119], v[32:47]
  s_xor_b32 m0, s86, 72704
  s_nop 0
  buffer_load_dwordx4 v15, s[12:15], s85 offen lds
  v_mfma_f32_32x32x16_bf16 v[48:63], v[100:103], a[116:119], v[48:63]
  s_waitcnt vmcnt(8) lgkmcnt(4)
  v_mfma_f32_32x32x16_bf16 v[32:47], v[80:83], a[120:123], v[32:47]
  v_mfma_f32_32x32x16_bf16 v[48:63], v[84:87], a[120:123], v[48:63]
  s_waitcnt vmcnt(6) lgkmcnt(0)
  v_mfma_f32_32x32x16_bf16 v[32:47], v[88:91], a[124:127], v[32:47]
  v_mfma_f32_32x32x16_bf16 v[48:63], v[92:95], a[124:127], v[48:63]
  v_and_b32 v7, 31, v1
  v_mul_u32_u24 v7, 96, v7
  v_lshrrev_b32 v3, 5, v1
  v_mul_u32_u24 v8, 12288, v3
  v_add_u32 v8, v7, v8
  s_mul_i32 s72, s60, 3072
  s_add_u32 s72, s72, 139264
  v_add_u32 v8, s72, v8
  s_nop 2
  v_cvt_pk_bf16_f32 v32, v32, v33
  v_cvt_pk_bf16_f32 v33, v34, v35
  v_cvt_pk_bf16_f32 v34, v36, v37
  v_cvt_pk_bf16_f32 v35, v38, v39
  v_cvt_pk_bf16_f32 v36, v40, v41
  v_cvt_pk_bf16_f32 v37, v42, v43
  v_cvt_pk_bf16_f32 v38, v44, v45
  v_cvt_pk_bf16_f32 v39, v46, v47
  v_mfma_f32_32x32x16_bf16 v[64:79], v[24:27], v[32:35], 0
  s_nop 0
  v_mfma_f32_32x32x16_bf16 v[64:79], v[28:31], v[36:39], v[64:79]
  v_cvt_pk_bf16_f32 v48, v48, v49
  v_cvt_pk_bf16_f32 v49, v50, v51
  v_cvt_pk_bf16_f32 v50, v52, v53
  v_cvt_pk_bf16_f32 v51, v54, v55
  v_cvt_pk_bf16_f32 v52, v56, v57
  v_cvt_pk_bf16_f32 v53, v58, v59
  v_cvt_pk_bf16_f32 v54, v60, v61
  v_cvt_pk_bf16_f32 v55, v62, v63
  ds_write_b128 v8, v[48:51] offset:64
  ds_write_b128 v8, v[52:55] offset:80
  v_lshrrev_b32 v7, 2, v1
  v_mul_u32_u24 v7, 96, v7
  v_and_b32 v4, 3, v1
  v_lshl_add_u32 v7, v4, 3, v7
  s_mul_i32 s72, s75, 12288
  s_add_u32 s72, s72, 139264
  v_add_u32 v7, s72, v7
  s_lshl_b32 s73, s74, 5
  v_add_u32 v9, s73, v7
  v_mov_b32 v100, 0x3f803f80
  v_mov_b32 v101, 0x3f803f80
  v_mov_b32 v102, 0x3f803f80
  v_mov_b32 v103, 0x3f803f80
  v_max3_f32 v136, v64, v65, v66
  v_min3_f32 v137, v64, v65, v66
  v_max3_f32 v136, v136, v67, v68
  v_min3_f32 v137, v137, v67, v68
  v_max3_f32 v136, v136, v69, v70
  v_min3_f32 v137, v137, v69, v70
  v_max3_f32 v136, v136, v71, v72
  v_min3_f32 v137, v137, v71, v72
  v_max3_f32 v136, v136, v73, v74
  v_min3_f32 v137, v137, v73, v74
  v_max3_f32 v136, v136, v75, v76
  v_min3_f32 v137, v137, v75, v76
  v_max3_f32 v136, v136, v77, v78
  v_min3_f32 v137, v137, v77, v78
  v_max_f32 v136, v136, v79
  v_min_f32 v137, v137, v79
  v_pk_mul_f32 v[136:137], v[136:137], s[80:81]
  v_pk_fma_f32 v[104:105], v[64:65], s[80:81], v[136:137] op_sel_hi:[1,1,0] neg_lo:[0,0,1] neg_hi:[0,0,1]
  v_pk_fma_f32 v[120:121], v[64:65], s[80:81], v[136:137] op_sel:[0,0,1] op_sel_hi:[1,1,1] neg_lo:[1,0,0] neg_hi:[1,0,0]
  v_pk_fma_f32 v[106:107], v[66:67], s[80:81], v[136:137] op_sel_hi:[1,1,0] neg_lo:[0,0,1] neg_hi:[0,0,1]
  v_pk_fma_f32 v[122:123], v[66:67], s[80:81], v[136:137] op_sel:[0,0,1] op_sel_hi:[1,1,1] neg_lo:[1,0,0] neg_hi:[1,0,0]
  v_pk_fma_f32 v[108:109], v[68:69], s[80:81], v[136:137] op_sel_hi:[1,1,0] neg_lo:[0,0,1] neg_hi:[0,0,1]
  v_pk_fma_f32 v[124:125], v[68:69], s[80:81], v[136:137] op_sel:[0,0,1] op_sel_hi:[1,1,1] neg_lo:[1,0,0] neg_hi:[1,0,0]
  v_pk_fma_f32 v[110:111], v[70:71], s[80:81], v[136:137] op_sel_hi:[1,1,0] neg_lo:[0,0,1] neg_hi:[0,0,1]
  v_pk_fma_f32 v[126:127], v[70:71], s[80:81], v[136:137] op_sel:[0,0,1] op_sel_hi:[1,1,1] neg_lo:[1,0,0] neg_hi:[1,0,0]
  v_pk_fma_f32 v[112:113], v[72:73], s[80:81], v[136:137] op_sel_hi:[1,1,0] neg_lo:[0,0,1] neg_hi:[0,0,1]
  v_pk_fma_f32 v[128:129], v[72:73], s[80:81], v[136:137] op_sel:[0,0,1] op_sel_hi:[1,1,1] neg_lo:[1,0,0] neg_hi:[1,0,0]
  v_pk_fma_f32 v[114:115], v[74:75], s[80:81], v[136:137] op_sel_hi:[1,1,0] neg_lo:[0,0,1] neg_hi:[0,0,1]
  v_pk_fma_f32 v[130:131], v[74:75], s[80:81], v[136:137] op_sel:[0,0,1] op_sel_hi:[1,1,1] neg_lo:[1,0,0] neg_hi:[1,0,0]
  v_pk_fma_f32 v[116:117], v[76:77], s[80:81], v[136:137] op_sel_hi:[1,1,0] neg_lo:[0,0,1] neg_hi:[0,0,1]
  v_pk_fma_f32 v[132:133], v[76:77], s[80:81], v[136:137] op_sel:[0,0,1] op_sel_hi:[1,1,1] neg_lo:[1,0,0] neg_hi:[1,0,0]
  v_pk_fma_f32 v[118:119], v[78:79], s[80:81], v[136:137] op_sel_hi:[1,1,0] neg_lo:[0,0,1] neg_hi:[0,0,1]
  v_pk_fma_f32 v[134:135], v[78:79], s[80:81], v[136:137] op_sel:[0,0,1] op_sel_hi:[1,1,1] neg_lo:[1,0,0] neg_hi:[1,0,0]
  v_exp_f32 v104, v104
  v_exp_f32 v105, v105
  v_exp_f32 v120, v120
  v_exp_f32 v121, v121
  v_exp_f32 v106, v106
  v_exp_f32 v107, v107
  v_exp_f32 v122, v122
  v_exp_f32 v123, v123
  v_exp_f32 v108, v108
  v_exp_f32 v109, v109
  v_exp_f32 v124, v124
  v_exp_f32 v125, v125
  v_pk_add_f32 v[138:139], v[104:105], v[106:107]
  v_pk_add_f32 v[140:141], v[120:121], v[122:123]
  v_exp_f32 v110, v110
  v_exp_f32 v111, v111
  v_exp_f32 v126, v126
  v_exp_f32 v127, v127
  v_pk_add_f32 v[138:139], v[138:139], v[108:109]
  v_pk_add_f32 v[140:141], v[140:141], v[124:125]
  s_add_u32 s55, s90, 0
  s_and_b32 s55, s55, 7
  s_mul_i32 s55, s55, 176128
  s_add_u32 s55, s55, s89
  buffer_load_dwordx4 a[140:143], v245, s[28:31], s55 offen offset:0
  buffer_load_dwordx4 a[144:147], v245, s[28:31], s55 offen offset:64
  buffer_load_dwordx4 a[148:151], v245, s[28:31], s55 offen offset:128
  v_exp_f32 v112, v112
  v_exp_f32 v113, v113
  v_exp_f32 v128, v128
  v_exp_f32 v129, v129
  v_pk_add_f32 v[138:139], v[138:139], v[110:111]
  v_pk_add_f32 v[140:141], v[140:141], v[126:127]
  v_exp_f32 v114, v114
  v_exp_f32 v115, v115
  v_exp_f32 v130, v130
  v_exp_f32 v131, v131
  v_pk_add_f32 v[138:139], v[138:139], v[112:113]
  v_pk_add_f32 v[140:141], v[140:141], v[128:129]
  v_exp_f32 v116, v116
  v_exp_f32 v117, v117
  v_exp_f32 v132, v132
  v_exp_f32 v133, v133
  v_pk_add_f32 v[138:139], v[138:139], v[114:115]
  v_pk_add_f32 v[140:141], v[140:141], v[130:131]
  v_exp_f32 v118, v118
  v_exp_f32 v119, v119
  v_exp_f32 v134, v134
  v_exp_f32 v135, v135
  v_pk_add_f32 v[138:139], v[138:139], v[116:117]
  v_pk_add_f32 v[140:141], v[140:141], v[132:133]
  s_lshl2_add_u32 m0, s54, 116736
  s_add_u32 s55, s96, 98304
  buffer_load_dwordx4 v252, s[40:43], s55 offen lds
  s_lshl2_add_u32 m0, s54, 117760
  s_add_u32 s55, s96, 147456
  buffer_load_dwordx4 v252, s[40:43], s55 offen lds
  v_pk_add_f32 v[138:139], v[138:139], v[118:119]
  v_pk_add_f32 v[140:141], v[140:141], v[134:135]
  v_add_f32 v138, v138, v139
  v_add_f32 v139, v140, v141
  v_rcp_f32 v138, v138
  v_rcp_f32 v139, v139
  buffer_load_dword v250, v253, s[36:39], s97 offen
  s_lshl2_add_u32 m0, s54, 114688
  s_add_u32 s55, s96, 0
  buffer_load_dwordx4 v252, s[40:43], s55 offen lds
  s_lshl2_add_u32 m0, s54, 115712
  s_add_u32 s55, s96, 49152
  buffer_load_dwordx4 v252, s[40:43], s55 offen lds
  v_pk_mul_f32 v[104:105], v[104:105], v[138:139] op_sel_hi:[1,0]
  v_pk_mul_f32 v[106:107], v[106:107], v[138:139] op_sel_hi:[1,0]
  v_pk_mul_f32 v[108:109], v[108:109], v[138:139] op_sel_hi:[1,0]
  v_pk_mul_f32 v[110:111], v[110:111], v[138:139] op_sel_hi:[1,0]
  v_cvt_pk_bf16_f32 v152, v104, v105
  v_cvt_pk_bf16_f32 v153, v106, v107
  v_cvt_pk_bf16_f32 v154, v108, v109
  v_cvt_pk_bf16_f32 v155, v110, v111
  ds_write_b128 v8, v[152:155] offset:0
  v_pk_mul_f32 v[112:113], v[112:113], v[138:139] op_sel_hi:[1,0]
  v_pk_mul_f32 v[114:115], v[114:115], v[138:139] op_sel_hi:[1,0]
  v_pk_mul_f32 v[116:117], v[116:117], v[138:139] op_sel_hi:[1,0]
  v_pk_mul_f32 v[118:119], v[118:119], v[138:139] op_sel_hi:[1,0]
  v_cvt_pk_bf16_f32 v156, v112, v113
  v_cvt_pk_bf16_f32 v157, v114, v115
  v_cvt_pk_bf16_f32 v158, v116, v117
  v_cvt_pk_bf16_f32 v159, v118, v119
  ds_write_b128 v8, v[156:159] offset:16
  v_pk_mul_f32 v[120:121], v[120:121], v[138:139] op_sel:[0,1] op_sel_hi:[1,1]
  v_pk_mul_f32 v[122:123], v[122:123], v[138:139] op_sel:[0,1] op_sel_hi:[1,1]
  v_pk_mul_f32 v[124:125], v[124:125], v[138:139] op_sel:[0,1] op_sel_hi:[1,1]
  v_pk_mul_f32 v[126:127], v[126:127], v[138:139] op_sel:[0,1] op_sel_hi:[1,1]
  v_cvt_pk_bf16_f32 v160, v120, v121
  v_cvt_pk_bf16_f32 v161, v122, v123
  v_cvt_pk_bf16_f32 v162, v124, v125
  v_cvt_pk_bf16_f32 v163, v126, v127
  ds_write_b128 v8, v[160:163] offset:32
  v_pk_mul_f32 v[128:129], v[128:129], v[138:139] op_sel:[0,1] op_sel_hi:[1,1]
  v_pk_mul_f32 v[130:131], v[130:131], v[138:139] op_sel:[0,1] op_sel_hi:[1,1]
  v_pk_mul_f32 v[132:133], v[132:133], v[138:139] op_sel:[0,1] op_sel_hi:[1,1]
  v_pk_mul_f32 v[134:135], v[134:135], v[138:139] op_sel:[0,1] op_sel_hi:[1,1]
  v_cvt_pk_bf16_f32 v164, v128, v129
  v_cvt_pk_bf16_f32 v165, v130, v131
  v_cvt_pk_bf16_f32 v166, v132, v133
  v_cvt_pk_bf16_f32 v167, v134, v135
  ds_write_b128 v8, v[164:167] offset:48
  s_lshl_b32 s72, s59, 2
  s_add_u32 s72, s72, s60
  s_lshl_b32 s53, s72, 14
  s_add_u32 s53, s53, 1048576
  s_lshl_b32 s72, s58, 10
  s_add_u32 s72, s72, s53
  s_mov_b32 s4, 0xaaaaaaaa
  s_mov_b32 s5, 0xaaaaaaaa
  s_mov_b32 s6, 0xcccccccc
  s_mov_b32 s7, 0xcccccccc
  s_waitcnt lgkmcnt(0)
  s_barrier
  ds_read_b64_tr_b16 v[32:33], v9 offset:0
  ds_read_b64_tr_b16 v[48:49], v7 offset:64
  ds_read_b64_tr_b16 v[34:35], v9 offset:1536
  ds_read_b64_tr_b16 v[50:51], v7 offset:1600
  ds_read_b64_tr_b16 v[36:37], v9 offset:3072
  ds_read_b64_tr_b16 v[52:53], v7 offset:3136
  ds_read_b64_tr_b16 v[38:39], v9 offset:4608
  ds_read_b64_tr_b16 v[54:55], v7 offset:4672
  ds_read_b64_tr_b16 v[40:41], v9 offset:6144
  ds_read_b64_tr_b16 v[56:57], v7 offset:6208
  ds_read_b64_tr_b16 v[42:43], v9 offset:7680
  ds_read_b64_tr_b16 v[58:59], v7 offset:7744
  ds_read_b64_tr_b16 v[44:45], v9 offset:9216
  ds_read_b64_tr_b16 v[60:61], v7 offset:9280
  ds_read_b64_tr_b16 v[46:47], v9 offset:10752
  ds_read_b64_tr_b16 v[62:63], v7 offset:10816
  s_waitcnt lgkmcnt(12)
  v_mfma_f32_16x16x32_bf16 v[68:71], v[32:35], v[100:103], 0
  v_mfma_f32_16x16x32_bf16 v[64:67], v[32:35], v[48:51], 0
  s_waitcnt lgkmcnt(8)
  v_mfma_f32_16x16x32_bf16 v[68:71], v[36:39], v[100:103], v[68:71]
  v_mfma_f32_16x16x32_bf16 v[64:67], v[36:39], v[52:55], v[64:67]
  s_waitcnt lgkmcnt(4)
  v_mfma_f32_16x16x32_bf16 v[68:71], v[40:43], v[100:103], v[68:71]
  v_mfma_f32_16x16x32_bf16 v[64:67], v[40:43], v[56:59], v[64:67]
  s_waitcnt lgkmcnt(0)
  v_mfma_f32_16x16x32_bf16 v[68:71], v[44:47], v[100:103], v[68:71]
  v_mfma_f32_16x16x32_bf16 v[64:67], v[44:47], v[60:63], v[64:67]
  v_add_u32 v7, 65536, v14
  s_nop 5
  v_cndmask_b32 v68, v68, v69, s[4:5]
  v_cndmask_b32 v70, v70, v71, s[4:5]
  v_cvt_pk_bf16_f32 v64, v64, v65
  v_cvt_pk_bf16_f32 v65, v66, v67
  v_cndmask_b32 v66, v68, v70, s[6:7]
  v_mov_b32 v67, s56
  buffer_store_dwordx4 v[64:67], v2, s[48:51], s72 offen sc1
  s_cmp_lg_u32 s60, 3
  s_cbranch_scc1 C_24
  s_lshl2_add_u32 s72, s59, s62
  s_mov_b64 exec, 1
  s_cmp_eq_u32 s57, 0
  s_cbranch_scc1 L_25
  buffer_store_dword v67, v1, s[48:51], s72 offen offset:1280
  s_branch L_26
L_25:
  buffer_store_dword v67, v1, s[48:51], s72 offen offset:1280 sc1
L_26:
  s_mov_b64 exec, -1
C_24:
  s_add_u32 s55, s90, 5
  s_and_b32 s55, s55, 7
  s_mul_i32 s55, s55, 176128
  s_add_u32 s55, s55, s89
  buffer_load_dwordx4 a[176:179], v244, s[24:27], s55 offen offset:0
  buffer_load_dwordx4 a[180:183], v244, s[24:27], s55 offen offset:64
  buffer_load_dwordx4 a[184:187], v244, s[24:27], s55 offen offset:128
  s_waitcnt vmcnt(12)
  s_barrier
  v_and_b32 v10, 15, v1
  v_lshrrev_b32 v16, 4, v1
  v_mul_u32_u24 v188, 12288, v16
  v_lshl_add_u32 v188, v10, 4, v188
  s_and_b32 s68, s59, 7
  s_lshl_b32 s68, s68, 8
  s_lshl_b32 s73, s60, 11
  s_add_u32 s68, s68, s73
  s_add_u32 s68, s68, 610304
  s_lshl_b32 s69, s58, 2
  s_add_u32 s69, s69, s76
  s_lshl_b32 s69, s69, 15
  s_lshl_b32 s73, s77, 6
  s_add_u32 s69, s69, s73
  v_lshlrev_b32 v20, 10, v10
  v_lshl_add_u32 v20, v16, 4, v20
  s_lshl_b32 s66, s58, 6
  s_lshr_b32 s67, s53, 4
  s_add_u32 s67, s67, 655360
  s_add_u32 s70, s67, s66
  s_add_u32 s66, s66, s53
  v_lshlrev_b32 v21, 2, v10
  ds_read_b64_tr_b16 v[80:81], v7 offset:0
  ds_read_b64_tr_b16 v[82:83], v7 offset:256
  ds_read_b64_tr_b16 v[84:85], v7 offset:1024
  ds_read_b64_tr_b16 v[86:87], v7 offset:1280
  ds_read_b64_tr_b16 v[88:89], v7 offset:2048
  ds_read_b64_tr_b16 v[90:91], v7 offset:2304
  ds_read_b64_tr_b16 v[92:93], v7 offset:3072
  ds_read_b64_tr_b16 v[94:95], v7 offset:3328
  s_waitcnt lgkmcnt(6)
  v_mfma_f32_32x32x16_bf16 v[32:47], v[80:83], a[0:3], 0
  ds_read_b64_tr_b16 v[80:81], v7 offset:4096
  ds_read_b64_tr_b16 v[82:83], v7 offset:4352
  s_waitcnt lgkmcnt(6)
  v_mfma_f32_32x32x16_bf16 v[32:47], v[84:87], a[4:7], v[32:47]
  buffer_load_dwordx4 v[168:171], v11, s[8:11], s69 offen
  buffer_load_dwordx4 v[172:175], v11, s[8:11], s69 offen offset:32
  ds_read_b64_tr_b16 v[84:85], v7 offset:5120
  ds_read_b64_tr_b16 v[86:87], v7 offset:5376
  s_waitcnt lgkmcnt(6)
  v_mfma_f32_32x32x16_bf16 v[32:47], v[88:91], a[8:11], v[32:47]
  ds_read_b64_tr_b16 v[88:89], v7 offset:6144
  ds_read_b64_tr_b16 v[90:91], v7 offset:6400
  s_waitcnt lgkmcnt(6)
  v_mfma_f32_32x32x16_bf16 v[32:47], v[92:95], a[12:15], v[32:47]
  ds_read_b64_tr_b16 v[92:93], v7 offset:7168
  ds_read_b64_tr_b16 v[94:95], v7 offset:7424
  s_waitcnt lgkmcnt(6)
  v_mfma_f32_32x32x16_bf16 v[32:47], v[80:83], a[16:19], v[32:47]
  ds_read_b64_tr_b16 v[80:81], v7 offset:8192
  ds_read_b64_tr_b16 v[82:83], v7 offset:8448
  s_waitcnt lgkmcnt(6)
  v_mfma_f32_32x32x16_bf16 v[32:47], v[84:87], a[20:23], v[32:47]
  ds_read_b64_tr_b16 v[84:85], v7 offset:9216
  ds_read_b64_tr_b16 v[86:87], v7 offset:9472
  s_waitcnt lgkmcnt(6)
  v_mfma_f32_32x32x16_bf16 v[32:47], v[88:91], a[24:27], v[32:47]
  ds_read_b64_tr_b16 v[88:89], v7 offset:10240
  ds_read_b64_tr_b16 v[90:91], v7 offset:10496
  s_waitcnt lgkmcnt(6)
  v_mfma_f32_32x32x16_bf16 v[32:47], v[92:95], a[28:31], v[32:47]
  ds_read_b64_tr_b16 v[92:93], v7 offset:11264
  ds_read_b64_tr_b16 v[94:95], v7 offset:11520
  s_waitcnt lgkmcnt(6)
  v_mfma_f32_32x32x16_bf16 v[32:47], v[80:83], a[32:35], v[32:47]
  ds_read_b64_tr_b16 v[80:81], v7 offset:12288
  ds_read_b64_tr_b16 v[82:83], v7 offset:12544
  s_waitcnt lgkmcnt(6)
  v_mfma_f32_32x32x16_bf16 v[32:47], v[84:87], a[36:39], v[32:47]
  ds_read_b64_tr_b16 v[84:85], v7 offset:13312
  ds_read_b64_tr_b16 v[86:87], v7 offset:13568
  s_waitcnt lgkmcnt(6)
  v_mfma_f32_32x32x16_bf16 v[32:47], v[88:91], a[40:43], v[32:47]
  ds_read_b64_tr_b16 v[88:89], v7 offset:14336
  ds_read_b64_tr_b16 v[90:91], v7 offset:14592
  s_waitcnt lgkmcnt(6)
  v_mfma_f32_32x32x16_bf16 v[32:47], v[92:95], a[44:47], v[32:47]
  ds_read_b64_tr_b16 v[92:93], v7 offset:15360
  ds_read_b64_tr_b16 v[94:95], v7 offset:15616
  s_waitcnt lgkmcnt(6)
  v_mfma_f32_32x32x16_bf16 v[32:47], v[80:83], a[48:51], v[32:47]
  ds_read_b64_tr_b16 v[80:81], v7 offset:16384
  ds_read_b64_tr_b16 v[82:83], v7 offset:16640
  s_waitcnt lgkmcnt(6)
  v_mfma_f32_32x32x16_bf16 v[32:47], v[84:87], a[52:55], v[32:47]
  ds_read_b64_tr_b16 v[84:85], v7 offset:17408
  ds_read_b64_tr_b16 v[86:87], v7 offset:17664
  s_waitcnt lgkmcnt(6)
  v_mfma_f32_32x32x16_bf16 v[32:47], v[88:91], a[56:59], v[32:47]
  ds_read_b64_tr_b16 v[88:89], v7 offset:18432
  ds_read_b64_tr_b16 v[90:91], v7 offset:18688
  s_waitcnt lgkmcnt(6)
  v_mfma_f32_32x32x16_bf16 v[32:47], v[92:95], a[60:63], v[32:47]
  ds_read_b64_tr_b16 v[92:93], v7 offset:19456
  ds_read_b64_tr_b16 v[94:95], v7 offset:19712
  s_waitcnt lgkmcnt(6)
  v_mfma_f32_32x32x16_bf16 v[32:47], v[80:83], a[64:67], v[32:47]
  ds_read_b64_tr_b16 v[80:81], v7 offset:20480
  ds_read_b64_tr_b16 v[82:83], v7 offset:20736
  s_waitcnt lgkmcnt(6)
  v_mfma_f32_32x32x16_bf16 v[32:47], v[84:87], a[68:71], v[32:47]
  ds_read_b64_tr_b16 v[84:85], v7 offset:21504
  ds_read_b64_tr_b16 v[86:87], v7 offset:21760
  s_waitcnt lgkmcnt(6)
  v_mfma_f32_32x32x16_bf16 v[32:47], v[88:91], a[72:75], v[32:47]
  ds_read_b64_tr_b16 v[88:89], v7 offset:22528
  ds_read_b64_tr_b16 v[90:91], v7 offset:22784
  s_waitcnt lgkmcnt(6)
  v_mfma_f32_32x32x16_bf16 v[32:47], v[92:95], a[76:79], v[32:47]
  ds_read_b64_tr_b16 v[92:93], v7 offset:23552
  ds_read_b64_tr_b16 v[94:95], v7 offset:23808
  s_waitcnt lgkmcnt(6)
  v_mfma_f32_32x32x16_bf16 v[32:47], v[80:83], a[80:83], v[32:47]
  s_add_u32 s55, s90, 0
  s_and_b32 s55, s55, 7
  s_mul_i32 s55, s55, 176128
  s_add_u32 s55, s55, s89
  buffer_load_dwordx4 a[128:131], v244, s[24:27], s55 offen offset:0
  buffer_load_dwordx4 a[132:135], v244, s[24:27], s55 offen offset:64
  buffer_load_dwordx4 a[136:139], v244, s[24:27], s55 offen offset:128
  ds_read_b64_tr_b16 v[80:81], v7 offset:24576
  ds_read_b64_tr_b16 v[82:83], v7 offset:24832
  s_waitcnt lgkmcnt(6)
  v_mfma_f32_32x32x16_bf16 v[32:47], v[84:87], a[84:87], v[32:47]
  ds_read_b64_tr_b16 v[84:85], v7 offset:25600
  ds_read_b64_tr_b16 v[86:87], v7 offset:25856
  s_waitcnt lgkmcnt(6)
  v_mfma_f32_32x32x16_bf16 v[32:47], v[88:91], a[88:91], v[32:47]
  ds_read_b64_tr_b16 v[88:89], v7 offset:26624
  ds_read_b64_tr_b16 v[90:91], v7 offset:26880
  s_waitcnt lgkmcnt(6)
  v_mfma_f32_32x32x16_bf16 v[32:47], v[92:95], a[92:95], v[32:47]
  ds_read_b64_tr_b16 v[92:93], v7 offset:27648
  ds_read_b64_tr_b16 v[94:95], v7 offset:27904
  s_waitcnt lgkmcnt(6)
  v_mfma_f32_32x32x16_bf16 v[32:47], v[80:83], a[96:99], v[32:47]
  ds_read_b64_tr_b16 v[80:81], v7 offset:28672
  ds_read_b64_tr_b16 v[82:83], v7 offset:28928
  s_waitcnt lgkmcnt(6)
  v_mfma_f32_32x32x16_bf16 v[32:47], v[84:87], a[100:103], v[32:47]
  ds_read_b64_tr_b16 v[84:85], v7 offset:29696
  ds_read_b64_tr_b16 v[86:87], v7 offset:29952
  s_waitcnt lgkmcnt(6)
  v_mfma_f32_32x32x16_bf16 v[32:47], v[88:91], a[104:107], v[32:47]
  ds_read_b64_tr_b16 v[88:89], v7 offset:30720
  ds_read_b64_tr_b16 v[90:91], v7 offset:30976
  s_waitcnt lgkmcnt(6)
  v_mfma_f32_32x32x16_bf16 v[32:47], v[92:95], a[108:111], v[32:47]
  ds_read_b64_tr_b16 v[92:93], v7 offset:31744
  ds_read_b64_tr_b16 v[94:95], v7 offset:32000
  s_waitcnt lgkmcnt(6)
  v_mfma_f32_32x32x16_bf16 v[32:47], v[80:83], a[112:115], v[32:47]
  s_waitcnt lgkmcnt(4)
  v_mfma_f32_32x32x16_bf16 v[32:47], v[84:87], a[116:119], v[32:47]
  s_waitcnt lgkmcnt(2)
  v_mfma_f32_32x32x16_bf16 v[32:47], v[88:91], a[120:123], v[32:47]
  s_waitcnt lgkmcnt(0)
  v_mfma_f32_32x32x16_bf16 v[32:47], v[92:95], a[124:127], v[32:47]
  buffer_load_dwordx4 v[176:179], v20, s[48:51], s66 offen sc1
  s_waitcnt vmcnt(10)
  s_barrier
  s_nop 8
  v_cvt_pk_bf16_f32 v32, v32, v33
  v_cvt_pk_bf16_f32 v33, v34, v35
  v_cvt_pk_bf16_f32 v34, v36, v37
  v_cvt_pk_bf16_f32 v35, v38, v39
  v_cvt_pk_bf16_f32 v36, v40, v41
  v_cvt_pk_bf16_f32 v37, v42, v43
  v_cvt_pk_bf16_f32 v38, v44, v45
  v_cvt_pk_bf16_f32 v39, v46, v47
  v_mfma_f32_32x32x16_bf16 v[64:79], v[24:27], v[32:35], 0
  s_nop 0
  v_mfma_f32_32x32x16_bf16 v[64:79], v[28:31], v[36:39], v[64:79]
  s_xor_b32 m0, s88, 0
  s_xor_b32 s55, s87, 0
  buffer_load_dwordx4 v13, s[20:23], s55 offen lds
  s_xor_b32 m0, s88, 1024
  s_xor_b32 s55, s87, 8192
  buffer_load_dwordx4 v13, s[20:23], s55 offen lds
  s_add_u32 s55, s90, 1
  s_and_b32 s55, s55, 7
  s_mul_i32 s55, s55, 176128
  s_add_u32 s55, s55, s89
  s_add_u32 m0, s54, 147456
  s_nop 0
  buffer_load_dwordx4 v244, s[24:27], s55 offen offset:0 lds
  s_add_u32 m0, s54, 155584
  s_nop 0
  buffer_load_dwordx4 v244, s[24:27], s55 offen offset:64 lds
  s_add_u32 m0, s54, 139136
  s_nop 0
  buffer_load_dwordx4 v244, s[24:27], s55 offen offset:128 lds
  s_mov_b32 s65, 0
  s_waitcnt vmcnt(5)
  v_cmp_ne_u32 vcc, s56, v179
  s_cbranch_vccz PD_27
  s_mov_b32 s65, 0
P_28:
  buffer_load_dwordx4 v[176:179], v20, s[48:51], s66 offen sc1
  s_add_u32 s65, s65, 1
  s_cmp_gt_u32 s65, 20000
  s_cbranch_scc1 PE_29
  s_waitcnt vmcnt(0)
  v_cmp_ne_u32 vcc, s56, v179
  s_cbranch_vccnz P_28
PE_29:
  s_waitcnt vmcnt(0)
PD_27:
  v_lshlrev_b32 v180, 16, v176
  v_and_b32 v181, 0xffff0000, v176
  v_lshlrev_b32 v182, 16, v177
  v_and_b32 v183, 0xffff0000, v177
  v_add_f32_dpp v178, v178, v178 row_ror:1 row_mask:0xf bank_mask:0xf
  v_add_f32_dpp v180, v180, v180 row_ror:1 row_mask:0xf bank_mask:0xf
  v_add_f32_dpp v181, v181, v181 row_ror:1 row_mask:0xf bank_mask:0xf
  v_add_f32_dpp v182, v182, v182 row_ror:1 row_mask:0xf bank_mask:0xf
  v_add_f32_dpp v183, v183, v183 row_ror:1 row_mask:0xf bank_mask:0xf
  v_add_f32_dpp v178, v178, v178 row_ror:2 row_mask:0xf bank_mask:0xf
  v_add_f32_dpp v180, v180, v180 row_ror:2 row_mask:0xf bank_mask:0xf
  v_add_f32_dpp v181, v181, v181 row_ror:2 row_mask:0xf bank_mask:0xf
  v_add_f32_dpp v182, v182, v182 row_ror:2 row_mask:0xf bank_mask:0xf
  v_add_f32_dpp v183, v183, v183 row_ror:2 row_mask:0xf bank_mask:0xf
  v_add_f32_dpp v178, v178, v178 row_ror:4 row_mask:0xf bank_mask:0xf
  v_add_f32_dpp v180, v180, v180 row_ror:4 row_mask:0xf bank_mask:0xf
  v_add_f32_dpp v181, v181, v181 row_ror:4 row_mask:0xf bank_mask:0xf
  v_add_f32_dpp v182, v182, v182 row_ror:4 row_mask:0xf bank_mask:0xf
  v_add_f32_dpp v183, v183, v183 row_ror:4 row_mask:0xf bank_mask:0xf
  v_add_f32_dpp v178, v178, v178 row_ror:8 row_mask:0xf bank_mask:0xf
  v_add_f32_dpp v180, v180, v180 row_ror:8 row_mask:0xf bank_mask:0xf
  v_add_f32_dpp v181, v181, v181 row_ror:8 row_mask:0xf bank_mask:0xf
  v_add_f32_dpp v182, v182, v182 row_ror:8 row_mask:0xf bank_mask:0xf
  v_add_f32_dpp v183, v183, v183 row_ror:8 row_mask:0xf bank_mask:0xf
  v_cvt_pk_bf16_f32 v176, v180, v181
  v_cvt_pk_bf16_f32 v177, v182, v183
  s_mov_b32 exec_lo, 0x00010001
  s_mov_b32 exec_hi, 0x00010001
  buffer_store_dwordx4 v[176:179], v1, s[48:51], s70 offen sc1
  s_mov_b64 exec, -1
  s_xor_b32 m0, s88, 2048
  s_xor_b32 s55, s87, 16384
  buffer_load_dwordx4 v13, s[20:23], s55 offen lds
  s_xor_b32 m0, s88, 3072
  s_xor_b32 s55, s87, 24576
  buffer_load_dwordx4 v13, s[20:23], s55 offen lds
  v_max3_f32 v136, v64, v65, v66
  v_min3_f32 v137, v64, v65, v66
  v_max3_f32 v136, v136, v67, v68
  v_min3_f32 v137, v137, v67, v68
  v_max3_f32 v136, v136, v69, v70
  v_min3_f32 v137, v137, v69, v70
  v_max3_f32 v136, v136, v71, v72
  v_min3_f32 v137, v137, v71, v72
  v_max3_f32 v136, v136, v73, v74
  v_min3_f32 v137, v137, v73, v74
  v_max3_f32 v136, v136, v75, v76
  v_min3_f32 v137, v137, v75, v76
  v_max3_f32 v136, v136, v77, v78
  v_min3_f32 v137, v137, v77, v78
  v_max_f32 v136, v136, v79
  v_min_f32 v137, v137, v79
  v_pk_mul_f32 v[136:137], v[136:137], s[80:81]
  v_pk_fma_f32 v[104:105], v[64:65], s[80:81], v[136:137] op_sel_hi:[1,1,0] neg_lo:[0,0,1] neg_hi:[0,0,1]
  v_pk_fma_f32 v[120:121], v[64:65], s[80:81], v[136:137] op_sel:[0,0,1] op_sel_hi:[1,1,1] neg_lo:[1,0,0] neg_hi:[1,0,0]
  v_pk_fma_f32 v[106:107], v[66:67], s[80:81], v[136:137] op_sel_hi:[1,1,0] neg_lo:[0,0,1] neg_hi:[0,0,1]
  v_pk_fma_f32 v[122:123], v[66:67], s[80:81], v[136:137] op_sel:[0,0,1] op_sel_hi:[1,1,1] neg_lo:[1,0,0] neg_hi:[1,0,0]
  v_pk_fma_f32 v[108:109], v[68:69], s[80:81], v[136:137] op_sel_hi:[1,1,0] neg_lo:[0,0,1] neg_hi:[0,0,1]
  v_pk_fma_f32 v[124:125], v[68:69], s[80:81], v[136:137] op_sel:[0,0,1] op_sel_hi:[1,1,1] neg_lo:[1,0,0] neg_hi:[1,0,0]
  v_pk_fma_f32 v[110:111], v[70:71], s[80:81], v[136:137] op_sel_hi:[1,1,0] neg_lo:[0,0,1] neg_hi:[0,0,1]
  v_pk_fma_f32 v[126:127], v[70:71], s[80:81], v[136:137] op_sel:[0,0,1] op_sel_hi:[1,1,1] neg_lo:[1,0,0] neg_hi:[1,0,0]
  v_pk_fma_f32 v[112:113], v[72:73], s[80:81], v[136:137] op_sel_hi:[1,1,0] neg_lo:[0,0,1] neg_hi:[0,0,1]
  v_pk_fma_f32 v[128:129], v[72:73], s[80:81], v[136:137] op_sel:[0,0,1] op_sel_hi:[1,1,1] neg_lo:[1,0,0] neg_hi:[1,0,0]
  v_pk_fma_f32 v[114:115], v[74:75], s[80:81], v[136:137] op_sel_hi:[1,1,0] neg_lo:[0,0,1] neg_hi:[0,0,1]
  v_pk_fma_f32 v[130:131], v[74:75], s[80:81], v[136:137] op_sel:[0,0,1] op_sel_hi:[1,1,1] neg_lo:[1,0,0] neg_hi:[1,0,0]
  v_pk_fma_f32 v[116:117], v[76:77], s[80:81], v[136:137] op_sel_hi:[1,1,0] neg_lo:[0,0,1] neg_hi:[0,0,1]
  v_pk_fma_f32 v[132:133], v[76:77], s[80:81], v[136:137] op_sel:[0,0,1] op_sel_hi:[1,1,1] neg_lo:[1,0,0] neg_hi:[1,0,0]
  v_pk_fma_f32 v[118:119], v[78:79], s[80:81], v[136:137] op_sel_hi:[1,1,0] neg_lo:[0,0,1] neg_hi:[0,0,1]
  v_pk_fma_f32 v[134:135], v[78:79], s[80:81], v[136:137] op_sel:[0,0,1] op_sel_hi:[1,1,1] neg_lo:[1,0,0] neg_hi:[1,0,0]
  s_add_u32 s55, s90, 4
  s_and_b32 s55, s55, 7
  s_mul_i32 s55, s55, 176128
  s_add_u32 s55, s55, s89
  buffer_load_dwordx4 a[164:167], v245, s[28:31], s55 offen offset:0
  buffer_load_dwordx4 a[168:171], v245, s[28:31], s55 offen offset:64
  buffer_load_dwordx4 a[172:175], v245, s[28:31], s55 offen offset:128
  v_exp_f32 v104, v104
  v_exp_f32 v105, v105
  v_exp_f32 v120, v120
  v_exp_f32 v121, v121
  v_exp_f32 v106, v106
  v_exp_f32 v107, v107
  v_exp_f32 v122, v122
  v_exp_f32 v123, v123
  v_exp_f32 v108, v108
  v_exp_f32 v109, v109
  v_exp_f32 v124, v124
  v_exp_f32 v125, v125
  v_pk_add_f32 v[138:139], v[104:105], v[106:107]
  v_pk_add_f32 v[140:141], v[120:121], v[122:123]
  v_exp_f32 v110, v110
  v_exp_f32 v111, v111
  v_exp_f32 v126, v126
  v_exp_f32 v127, v127
  v_pk_add_f32 v[138:139], v[138:139], v[108:109]
  v_pk_add_f32 v[140:141], v[140:141], v[124:125]
  v_exp_f32 v112, v112
  v_exp_f32 v113, v113
  v_exp_f32 v128, v128
  v_exp_f32 v129, v129
  v_pk_add_f32 v[138:139], v[138:139], v[110:111]
  v_pk_add_f32 v[140:141], v[140:141], v[126:127]
  v_exp_f32 v114, v114
  v_exp_f32 v115, v115
  v_exp_f32 v130, v130
  v_exp_f32 v131, v131
  v_pk_add_f32 v[138:139], v[138:139], v[112:113]
  v_pk_add_f32 v[140:141], v[140:141], v[128:129]
  v_exp_f32 v116, v116
  v_exp_f32 v117, v117
  v_exp_f32 v132, v132
  v_exp_f32 v133, v133
  v_pk_add_f32 v[138:139], v[138:139], v[114:115]
  v_pk_add_f32 v[140:141], v[140:141], v[130:131]
  v_exp_f32 v118, v118
  v_exp_f32 v119, v119
  v_exp_f32 v134, v134
  v_exp_f32 v135, v135
  v_pk_add_f32 v[138:139], v[138:139], v[116:117]
  v_pk_add_f32 v[140:141], v[140:141], v[132:133]
  v_pk_add_f32 v[138:139], v[138:139], v[118:119]
  v_pk_add_f32 v[140:141], v[140:141], v[134:135]
  v_add_f32 v138, v138, v139
  v_add_f32 v139, v140, v141
  v_rcp_f32 v138, v138
  v_rcp_f32 v139, v139
  s_nop 0
  v_pk_mul_f32 v[104:105], v[104:105], v[138:139] op_sel_hi:[1,0]
  v_pk_mul_f32 v[106:107], v[106:107], v[138:139] op_sel_hi:[1,0]
  v_pk_mul_f32 v[108:109], v[108:109], v[138:139] op_sel_hi:[1,0]
  v_pk_mul_f32 v[110:111], v[110:111], v[138:139] op_sel_hi:[1,0]
  v_pk_mul_f32 v[112:113], v[112:113], v[138:139] op_sel_hi:[1,0]
  v_pk_mul_f32 v[114:115], v[114:115], v[138:139] op_sel_hi:[1,0]
  v_pk_mul_f32 v[116:117], v[116:117], v[138:139] op_sel_hi:[1,0]
  v_pk_mul_f32 v[118:119], v[118:119], v[138:139] op_sel_hi:[1,0]
  v_pk_mul_f32 v[120:121], v[120:121], v[138:139] op_sel:[0,1] op_sel_hi:[1,1]
  v_pk_mul_f32 v[122:123], v[122:123], v[138:139] op_sel:[0,1] op_sel_hi:[1,1]
  v_pk_mul_f32 v[124:125], v[124:125], v[138:139] op_sel:[0,1] op_sel_hi:[1,1]
  v_pk_mul_f32 v[126:127], v[126:127], v[138:139] op_sel:[0,1] op_sel_hi:[1,1]
  v_pk_mul_f32 v[128:129], v[128:129], v[138:139] op_sel:[0,1] op_sel_hi:[1,1]
  v_pk_mul_f32 v[130:131], v[130:131], v[138:139] op_sel:[0,1] op_sel_hi:[1,1]
  v_pk_mul_f32 v[132:133], v[132:133], v[138:139] op_sel:[0,1] op_sel_hi:[1,1]
  v_pk_mul_f32 v[134:135], v[134:135], v[138:139] op_sel:[0,1] op_sel_hi:[1,1]
  v_cvt_pk_bf16_f32 v152, v104, v105
  v_cvt_pk_bf16_f32 v153, v106, v107
  v_cvt_pk_bf16_f32 v154, v108, v109
  v_cvt_pk_bf16_f32 v155, v110, v111
  v_cvt_pk_bf16_f32 v156, v112, v113
  v_cvt_pk_bf16_f32 v157, v114, v115
  v_cvt_pk_bf16_f32 v158, v116, v117
  v_cvt_pk_bf16_f32 v159, v118, v119
  v_cvt_pk_bf16_f32 v160, v120, v121
  v_cvt_pk_bf16_f32 v161, v122, v123
  v_cvt_pk_bf16_f32 v162, v124, v125
  v_cvt_pk_bf16_f32 v163, v126, v127
  v_cvt_pk_bf16_f32 v164, v128, v129
  v_cvt_pk_bf16_f32 v165, v130, v131
  v_cvt_pk_bf16_f32 v166, v132, v133
  v_cvt_pk_bf16_f32 v167, v134, v135
  s_cmp_ge_u32 s99, 16
  s_cbranch_scc1 C_30
  s_lshl_b32 s70, s60, 8
  s_add_u32 s70, s70, 107520
  v_add_u32 v144, s70, v253
  v_and_b32 v145, 48, v1
  v_add_u32 v145, s70, v145
  v_lshrrev_b32 v146, 4, v1
  v_bfe_u32 v147, v1, 2, 2
  v_lshl_add_u32 v146, v146, 3, v147
  v_lshlrev_b32 v146, 7, v146
  v_and_b32 v147, 3, v1
  v_lshl_add_u32 v146, v147, 3, v146
  s_lshl_b32 s70, s60, 5
  s_add_u32 s70, s70, 114688
  v_add_u32 v146, s70, v146
  s_waitcnt vmcnt(63)
  v_lshlrev_b32 v108, 16, v250
  v_and_b32 v109, 0xffff0000, v250
  v_mul_f32 v110, 0xbfb8aa3b, v108
  v_mul_f32 v111, 0xbfb8aa3b, v109
  v_exp_f32 v110, v110
  v_exp_f32 v111, v111
  v_mov_b32 v148, 0x07060501
  v_add_f32 v110, 1.0, v110
  v_add_f32 v111, 1.0, v111
  v_rcp_f32 v110, v110
  v_rcp_f32 v111, v111
  v_mov_b32 v149, 0x07060502
  v_mul_f32 v110, v110, v108
  v_mul_f32 v111, v111, v109
  v_cvt_pk_bf16_f32 v104, v110, v111
  v_mov_b32 v150, 0x07060503
  ds_write_b32 v144, v104
  ds_read_b128 v[112:115], v145 offset:0
  ds_read_b128 v[116:119], v145 offset:64
  ds_read_b128 v[120:123], v145 offset:128
  ds_read_b128 v[124:127], v145 offset:192
  ds_read_b64_tr_b16 v[128:129], v146 offset:0
  ds_read_b64_tr_b16 v[130:131], v146 offset:512
  ds_read_b64_tr_b16 v[132:133], v146 offset:4096
  ds_read_b64_tr_b16 v[134:135], v146 offset:4608
  ds_read_b64_tr_b16 v[136:137], v146 offset:8192
  ds_read_b64_tr_b16 v[138:139], v146 offset:8704
  ds_read_b64_tr_b16 v[140:141], v146 offset:12288
  ds_read_b64_tr_b16 v[142:143], v146 offset:12800
  v_mov_b32 v107, s56
  s_waitcnt lgkmcnt(6)
  v_mfma_f32_16x16x32_bf16 v[96:99], v[128:131], v[112:115], 0
  s_waitcnt lgkmcnt(4)
  v_mfma_f32_16x16x32_bf16 v[96:99], v[132:135], v[116:119], v[96:99]
  s_waitcnt lgkmcnt(2)
  v_mfma_f32_16x16x32_bf16 v[96:99], v[136:139], v[120:123], v[96:99]
  s_waitcnt lgkmcnt(0)
  v_mfma_f32_16x16x32_bf16 v[96:99], v[140:143], v[124:127], v[96:99]
  s_mov_b32 exec_lo, 0x00010001
  s_mov_b32 exec_hi, 0x00010001
  s_nop 5
  v_perm_b32 v104, v96, v99, v148
  v_perm_b32 v105, v97, v99, v149
  v_perm_b32 v106, v98, v99, v150
  buffer_store_dwordx4 v[104:107], v1, s[48:51], s98 offen sc1
  s_mov_b64 exec, -1
C_30:
  s_xor_b32 m0, s88, 4096
  s_xor_b32 s55, s87, 32768
  buffer_load_dwordx4 v13, s[20:23], s55 offen lds
  s_xor_b32 m0, s88, 5120
  s_xor_b32 s55, s87, 40960
  buffer_load_dwordx4 v13, s[20:23], s55 offen lds
  s_xor_b32 m0, s88, 6144
  s_xor_b32 s55, s87, 49152
  buffer_load_dwordx4 v13, s[20:23], s55 offen lds
  s_xor_b32 m0, s88, 7168
  s_xor_b32 s55, s87, 57344
  buffer_load_dwordx4 v13, s[20:23], s55 offen lds
  s_xor_b32 m0, s88, 32768
  s_xor_b32 s55, s87, 262144
  buffer_load_dwordx4 v13, s[20:23], s55 offen lds
  s_xor_b32 m0, s88, 33792
  s_xor_b32 s55, s87, 270336
  buffer_load_dwordx4 v13, s[20:23], s55 offen lds
  s_xor_b32 m0, s88, 34816
  s_xor_b32 s55, s87, 278528
  buffer_load_dwordx4 v13, s[20:23], s55 offen lds
  s_xor_b32 m0, s88, 35840
  s_xor_b32 s55, s87, 286720
  buffer_load_dwordx4 v13, s[20:23], s55 offen lds
  s_xor_b32 m0, s88, 36864
  s_xor_b32 s55, s87, 294912
  buffer_load_dwordx4 v13, s[20:23], s55 offen lds
  s_xor_b32 m0, s88, 37888
  s_xor_b32 s55, s87, 303104
  buffer_load_dwordx4 v13, s[20:23], s55 offen lds
  s_xor_b32 m0, s88, 38912
  s_xor_b32 s55, s87, 311296
  buffer_load_dwordx4 v13, s[20:23], s55 offen lds
  s_xor_b32 m0, s88, 39936
  s_xor_b32 s55, s87, 319488
  buffer_load_dwordx4 v13, s[20:23], s55 offen lds
  buffer_load_dword v22, v21, s[48:51], s62 offen offset:1280 sc1
  buffer_load_dwordx4 v[184:187], v2, s[48:51], s67 offen sc1
  v_mul_u32_u24 v7, 80, v10
  v_lshl_add_u32 v7, v16, 3, v7
  s_mul_i32 s72, s75, 1280
  s_lshl_b32 s73, s74, 5
  s_add_u32 s72, s72, s73
  s_add_u32 s72, s72, 111360
  v_add_u32 v7, s72, v7
  v_lshl_add_u32 v8, v16, 2, v4
  s_lshl_b32 s72, s60, 5
  s_add_u32 s72, s72, 113920
  v_lshl_add_u32 v8, v8, 1, s72
  v_lshlrev_b32 v189, 4, v10
  v_lshl_add_u32 v189, v16, 2, v189
  s_lshl_b32 s73, s60, 8
  s_add_u32 s73, s73, 110336
  v_add_u32 v189, s73, v189
  v_bfe_u32 v18, v1, 3, 2
  v_lshl_add_u32 v18, v18, 2, v4
  v_mul_u32_u24 v18, 80, v18
  v_mul_u32_u24 v19, 1280, v3
  v_add_u32 v18, v18, v19
  v_add_u32 v18, 111360, v18
  v_bfe_u32 v19, v1, 2, 1
  v_cmp_eq_u32 vcc, v19, v3
  v_mov_b32 v19, 114048
  s_nop 0
  v_cndmask_b32 v18, v19, v18, vcc
  v_lshlrev_b32 v19, 6, v3
  v_add_u32 v19, 113920, v19
L_red:
  s_mov_b32 s65, 0
  s_waitcnt vmcnt(0)
  v_cmp_ne_u32 vcc, s56, v187
  s_cbranch_vccz PD_31
  s_mov_b32 s65, 0
P_32:
  buffer_load_dwordx4 v[184:187], v2, s[48:51], s67 offen sc1
  s_add_u32 s65, s65, 1
  s_cmp_gt_u32 s65, 20000
  s_cbranch_scc1 PE_33
  s_waitcnt vmcnt(0)
  v_cmp_ne_u32 vcc, s56, v187
  s_cbranch_vccnz P_32
PE_33:
  s_waitcnt vmcnt(0)
PD_31:
  s_add_u32 s55, s90, 2
  s_and_b32 s55, s55, 7
  s_mul_i32 s55, s55, 176128
  s_add_u32 s55, s55, s89
  s_add_u32 m0, s54, 65536
  s_nop 0
  buffer_load_dwordx4 v244, s[24:27], s55 offen offset:0 lds
  s_add_u32 m0, s54, 73664
  s_nop 0
  buffer_load_dwordx4 v244, s[24:27], s55 offen offset:64 lds
  s_add_u32 m0, s54, 81792
  s_nop 0
  buffer_load_dwordx4 v244, s[24:27], s55 offen offset:128 lds
  v_cvt_pk_bf16_f32 v64, v186, v186
  ds_write_b64 v7, v[184:185]
  ds_write_b16 v8, v64
  s_mov_b32 s65, 0
  s_waitcnt vmcnt(4)
  v_cmp_ne_u32 vcc, s56, v22
  s_cbranch_vccz PD_34
  s_mov_b32 s65, 0
P_35:
  buffer_load_dword v22, v21, s[48:51], s62 offen offset:1280 sc1
  s_add_u32 s65, s65, 1
  s_cmp_gt_u32 s65, 20000
  s_cbranch_scc1 PE_36
  s_waitcnt vmcnt(0)
  v_cmp_ne_u32 vcc, s56, v22
  s_cbranch_vccnz P_35
PE_36:
  s_waitcnt vmcnt(0)
PD_34:
  s_waitcnt lgkmcnt(0)
  s_barrier
  ds_read_b128 v[32:35], v18 offset:0
  ds_read_b128 v[36:39], v18 offset:16
  ds_read_b128 v[40:43], v18 offset:32
  ds_read_b128 v[44:47], v18 offset:48
  ds_read_b128 v[48:51], v19 offset:0
  ds_read_b128 v[52:55], v19 offset:16
  ds_read_b128 v[56:59], v19 offset:32
  ds_read_b128 v[60:63], v19 offset:48
  s_lshl_b32 s72, s60, 15
  s_lshl_b32 s73, s59, 11
  s_add_u32 s72, s72, s73
  s_add_u32 s72, s72, s63
  v_mov_b32 v80, 0x358637bd
  s_waitcnt lgkmcnt(4)
  v_mfma_f32_32x32x16_bf16 v[64:79], v[32:35], v[152:155], 0
  v_mfma_f32_32x32x16_bf16 v[64:79], v[36:39], v[156:159], v[64:79]
  v_mfma_f32_32x32x16_bf16 v[64:79], v[40:43], v[160:163], v[64:79]
  v_mfma_f32_32x32x16_bf16 v[64:79], v[44:47], v[164:167], v[64:79]
  s_waitcnt lgkmcnt(0)
  v_dot2_f32_bf16 v80, v152, v48, v80
  v_dot2_f32_bf16 v81, v153, v49, 0
  v_dot2_f32_bf16 v80, v154, v50, v80
  v_dot2_f32_bf16 v81, v155, v51, v81
  v_dot2_f32_bf16 v80, v156, v52, v80
  v_dot2_f32_bf16 v81, v157, v53, v81
  v_dot2_f32_bf16 v80, v158, v54, v80
  v_dot2_f32_bf16 v81, v159, v55, v81
  v_dot2_f32_bf16 v80, v160, v56, v80
  v_dot2_f32_bf16 v81, v161, v57, v81
  v_dot2_f32_bf16 v80, v162, v58, v80
  v_dot2_f32_bf16 v81, v163, v59, v81
  v_dot2_f32_bf16 v80, v164, v60, v80
  v_dot2_f32_bf16 v81, v165, v61, v81
  v_dot2_f32_bf16 v80, v166, v62, v80
  v_dot2_f32_bf16 v81, v167, v63, v81
  v_lshlrev_b32 v190, 5, v3
  s_lshl_b32 s73, s75, 7
  s_add_u32 s73, s73, 110336
  v_add_u32 v190, s73, v190
  v_add_f32 v80, v80, v81
  v_rcp_f32 v80, v80
  s_nop 0
  v_pk_mul_f32 v[64:65], v[64:65], v[80:81] op_sel_hi:[1,0]
  v_pk_mul_f32 v[66:67], v[66:67], v[80:81] op_sel_hi:[1,0]
  v_pk_mul_f32 v[68:69], v[68:69], v[80:81] op_sel_hi:[1,0]
  v_pk_mul_f32 v[70:71], v[70:71], v[80:81] op_sel_hi:[1,0]
  v_pk_mul_f32 v[72:73], v[72:73], v[80:81] op_sel_hi:[1,0]
  v_pk_mul_f32 v[74:75], v[74:75], v[80:81] op_sel_hi:[1,0]
  v_pk_mul_f32 v[76:77], v[76:77], v[80:81] op_sel_hi:[1,0]
  v_pk_mul_f32 v[78:79], v[78:79], v[80:81] op_sel_hi:[1,0]
  v_cvt_pk_bf16_f32 v64, v64, v65
  v_cvt_pk_bf16_f32 v65, v66, v67
  v_cvt_pk_bf16_f32 v66, v68, v69
  v_cvt_pk_bf16_f32 v67, v70, v71
  v_cvt_pk_bf16_f32 v68, v72, v73
  v_cvt_pk_bf16_f32 v69, v74, v75
  v_cvt_pk_bf16_f32 v70, v76, v77
  v_cvt_pk_bf16_f32 v71, v78, v79
  s_cmp_eq_u32 s57, 0
  s_cbranch_scc1 L_37
  buffer_store_dwordx4 v[64:67], v2, s[48:51], s72 offen nt
  buffer_store_dwordx4 v[68:71], v2, s[48:51], s72 offen offset:1024 nt
  s_branch L_38
L_37:
  buffer_store_dwordx4 v[64:67], v2, s[48:51], s72 offen sc1
  buffer_store_dwordx4 v[68:71], v2, s[48:51], s72 offen offset:1024 sc1
L_38:
  s_lshl_b32 s72, s60, 6
  s_lshl_b32 s73, s59, 2
  s_add_u32 s72, s72, s73
  s_add_u32 s72, s72, s62
  buffer_load_dwordx4 v[240:243], v188, s[48:51], s68 offen sc1
  s_add_u32 s55, s90, 4
  s_and_b32 s55, s55, 7
  s_mul_i32 s55, s55, 176128
  s_add_u32 s55, s55, s89
  buffer_load_dwordx4 a[152:155], v244, s[24:27], s55 offen offset:0
  buffer_load_dwordx4 a[156:159], v244, s[24:27], s55 offen offset:64
  buffer_load_dwordx4 a[160:163], v244, s[24:27], s55 offen offset:128
  v_mov_b32 v3, 0
  v_mov_b32 v4, s56
  s_waitcnt vmcnt(4)
  s_mov_b64 exec, 1
  s_cmp_eq_u32 s57, 0
  s_cbranch_scc1 L_39
  buffer_store_dword v4, v3, s[48:51], s72 offen offset:256
  s_branch L_40
L_39:
  buffer_store_dword v4, v3, s[48:51], s72 offen offset:256 sc1
L_40:
  s_mov_b64 exec, -1
  s_or_b32 s72, s2, s60
  s_cmp_lg_u32 s72, 0
  s_cbranch_scc1 C_41
  s_mov_b64 exec, 1
  buffer_store_dword v4, v3, s[48:51], 0 offen sc1
  s_mov_b64 exec, -1
C_41:
  v_lshlrev_b32 v16, 16, v168
  v_and_b32 v17, 0xffff0000, v168
  v_lshlrev_b32 v18, 16, v169
  v_and_b32 v19, 0xffff0000, v169
  v_lshlrev_b32 v20, 16, v170
  v_and_b32 v21, 0xffff0000, v170
  v_lshlrev_b32 v22, 16, v171
  v_and_b32 v23, 0xffff0000, v171
  v_lshlrev_b32 v24, 16, v172
  v_and_b32 v25, 0xffff0000, v172
  v_lshlrev_b32 v26, 16, v173
  v_and_b32 v27, 0xffff0000, v173
  v_lshlrev_b32 v28, 16, v174
  v_and_b32 v29, 0xffff0000, v174
  v_lshlrev_b32 v30, 16, v175
  v_and_b32 v31, 0xffff0000, v175
  v_and_b32 v4, 3, v1
  v_bfe_u32 v5, v1, 4, 1
  v_lshlrev_b32 v5, 5, v5
  v_and_b32 v6, 1, v1
  v_lshl_add_u32 v5, v6, 4, v5
  v_bfe_u32 v6, v1, 1, 1
  v_lshl_add_u32 v5, v6, 3, v5
  v_bfe_u32 v6, v1, 2, 2
  v_lshl_add_u32 v5, v6, 6, v5
  v_lshrrev_b32 v3, 5, v1
  v_lshl_add_u32 v8, v3, 11, v5
  s_mul_i32 s72, s75, 33280
  s_xor_b32 s73, s72, 512
  v_add_u32 v9, s73, v8
  v_add_u32 v8, s72, v8
  v_and_b32 v7, 7, v1
  v_lshlrev_b32 v7, 2, v7
  s_lshl_b32 s72, s76, 6
  s_lshl_b32 s73, s75, 5
  s_add_u32 s72, s72, s73
  s_add_u32 s72, s72, s62
  s_lshl_b32 s91, s76, 15
  s_lshl_b32 s73, s75, 14
  s_add_u32 s91, s91, s73
  s_add_u32 s91, s91, s63
  s_add_u32 s55, s90, 2
  s_and_b32 s55, s55, 7
  s_mul_i32 s55, s55, 176128
  s_add_u32 s55, s55, s89
  s_add_u32 m0, s54, 69632
  s_nop 0
  buffer_load_dwordx4 v245, s[28:31], s55 offen offset:0 lds
  s_add_u32 m0, s54, 77760
  s_nop 0
  buffer_load_dwordx4 v245, s[28:31], s55 offen offset:64 lds
  s_add_u32 m0, s54, 85888
  s_nop 0
  buffer_load_dwordx4 v245, s[28:31], s55 offen offset:128 lds
  s_mov_b32 s65, 0
P_42:
  buffer_load_dword v4, v7, s[48:51], s72 offen offset:256 sc1
  s_add_u32 s65, s65, 1
  s_cmp_gt_u32 s65, 20000
  s_cbranch_scc1 PE_43
  s_waitcnt vmcnt(0)
  v_cmp_ne_u32 vcc, s56, v4
  s_cbranch_vccnz P_42
PE_43:
  s_waitcnt vmcnt(0)
  s_add_u32 s55, s91, 0
  buffer_load_dwordx4 a[0:3], v2, s[48:51], s55 offen offset:0 sc1
  s_add_u32 s55, s91, 0
  buffer_load_dwordx4 a[4:7], v2, s[48:51], s55 offen offset:1024 sc1
  s_add_u32 s55, s91, 0
  buffer_load_dwordx4 a[8:11], v2, s[48:51], s55 offen offset:2048 sc1
  s_add_u32 s55, s91, 0
  buffer_load_dwordx4 a[12:15], v2, s[48:51], s55 offen offset:3072 sc1
  s_add_u32 s55, s91, 4096
  buffer_load_dwordx4 a[16:19], v2, s[48:51], s55 offen offset:0 sc1
  s_add_u32 s55, s91, 4096
  buffer_load_dwordx4 a[20:23], v2, s[48:51], s55 offen offset:1024 sc1
  s_add_u32 s55, s91, 4096
  buffer_load_dwordx4 a[24:27], v2, s[48:51], s55 offen offset:2048 sc1
  s_add_u32 s55, s91, 4096
  buffer_load_dwordx4 a[28:31], v2, s[48:51], s55 offen offset:3072 sc1
  s_mov_b32 s65, 0
  s_waitcnt vmcnt(16)
  v_cmp_ne_u32 vcc, s56, v243
  s_cbranch_vccz PD_44
  s_mov_b32 s65, 0
P_45:
  buffer_load_dwordx4 v[240:243], v188, s[48:51], s68 offen sc1
  s_add_u32 s65, s65, 1
  s_cmp_gt_u32 s65, 20000
  s_cbranch_scc1 PE_46
  s_waitcnt vmcnt(0)
  v_cmp_ne_u32 vcc, s56, v243
  s_cbranch_vccnz P_45
PE_46:
  s_waitcnt vmcnt(0)
PD_44:
  s_cmp_eq_u32 s60, 2
  s_cselect_b32 s72, 1.0, 0
  s_mov_b32 s70, 0x0c0c0400
  s_mov_b32 s71, 0x0401000c
  v_perm_b32 v243, v241, v240, s70
  v_perm_b32 v243, v242, v243, s71
  v_permlane32_swap_b32 v240, v242
  s_nop 0
  v_permlane32_swap_b32 v241, v243
  v_add_f32 v240, v240, v242
  v_add_f32 v241, v241, v243
  s_nop 1
  v_permlane16_swap_b32 v240, v241
  v_add_f32 v240, v240, v241
  v_cvt_pk_bf16_f32 v240, v240, v240
  v_and_b32 v240, 0xffff0000, v240
  v_add_f32 v240, s72, v240
  v_cvt_pk_bf16_f32 v240, v240, v240
  v_and_b32 v240, 0xffff0000, v240
  ds_write_b32 v189, v240
  s_waitcnt lgkmcnt(0)
  s_barrier
  ds_read_b64_tr_b16 v[64:65], v9 offset:0
  ds_read_b64_tr_b16 v[66:67], v9 offset:256
  ds_read_b64_tr_b16 v[68:69], v8 offset:0
  ds_read_b64_tr_b16 v[70:71], v8 offset:256
  ds_read_b64_tr_b16 v[72:73], v9 offset:1024
  ds_read_b64_tr_b16 v[74:75], v9 offset:1280
  ds_read_b64_tr_b16 v[76:77], v8 offset:1024
  ds_read_b64_tr_b16 v[78:79], v8 offset:1280
  ds_read_b64_tr_b16 v[80:81], v9 offset:4096
  ds_read_b64_tr_b16 v[82:83], v9 offset:4352
  ds_read_b64_tr_b16 v[84:85], v8 offset:4096
  ds_read_b64_tr_b16 v[86:87], v8 offset:4352
  s_waitcnt vmcnt(7) lgkmcnt(8)
  v_mfma_f32_32x32x16_bf16 v[48:63], v[64:67], a[0:3], 0
  s_add_u32 s55, s91, 8192
  buffer_load_dwordx4 a[32:35], v2, s[48:51], s55 offen offset:0 sc1
  v_mfma_f32_32x32x16_bf16 v[32:47], v[68:71], a[0:3], 0
  ds_read_b64_tr_b16 v[64:65], v9 offset:5120
  ds_read_b64_tr_b16 v[66:67], v9 offset:5376
  ds_read_b64_tr_b16 v[68:69], v8 offset:5120
  ds_read_b64_tr_b16 v[70:71], v8 offset:5376
  s_waitcnt vmcnt(7) lgkmcnt(8)
  v_mfma_f32_32x32x16_bf16 v[48:63], v[72:75], a[4:7], v[48:63]
  s_add_u32 s55, s91, 8192
  buffer_load_dwordx4 a[36:39], v2, s[48:51], s55 offen offset:1024 sc1
  v_mfma_f32_32x32x16_bf16 v[32:47], v[76:79], a[4:7], v[32:47]
  ds_read_b64_tr_b16 v[72:73], v9 offset:8192
  ds_read_b64_tr_b16 v[74:75], v9 offset:8448
  ds_read_b64_tr_b16 v[76:77], v8 offset:8192
  ds_read_b64_tr_b16 v[78:79], v8 offset:8448
  s_waitcnt vmcnt(7) lgkmcnt(8)
  v_mfma_f32_32x32x16_bf16 v[48:63], v[80:83], a[8:11], v[48:63]
  s_add_u32 s55, s91, 8192
  buffer_load_dwordx4 a[40:43], v2, s[48:51], s55 offen offset:2048 sc1
  ds_read_b128 v[104:107], v190 offset:0
  ds_read_b128 v[108:111], v190 offset:16
  ds_read_b128 v[112:115], v190 offset:64
  ds_read_b128 v[116:119], v190 offset:80
  v_mfma_f32_32x32x16_bf16 v[32:47], v[84:87], a[8:11], v[32:47]
  ds_read_b64_tr_b16 v[80:81], v9 offset:9216
  ds_read_b64_tr_b16 v[82:83], v9 offset:9472
  ds_read_b64_tr_b16 v[84:85], v8 offset:9216
  ds_read_b64_tr_b16 v[86:87], v8 offset:9472
  s_waitcnt vmcnt(7) lgkmcnt(12)
  v_mfma_f32_32x32x16_bf16 v[48:63], v[64:67], a[12:15], v[48:63]
  s_add_u32 s55, s91, 8192
  buffer_load_dwordx4 a[44:47], v2, s[48:51], s55 offen offset:3072 sc1
  v_mfma_f32_32x32x16_bf16 v[32:47], v[68:71], a[12:15], v[32:47]
  ds_read_b64_tr_b16 v[64:65], v9 offset:12288
  ds_read_b64_tr_b16 v[66:67], v9 offset:12544
  ds_read_b64_tr_b16 v[68:69], v8 offset:12288
  ds_read_b64_tr_b16 v[70:71], v8 offset:12544
  s_waitcnt vmcnt(7) lgkmcnt(12)
  v_mfma_f32_32x32x16_bf16 v[48:63], v[72:75], a[16:19], v[48:63]
  s_add_u32 s55, s91, 12288
  buffer_load_dwordx4 a[48:51], v2, s[48:51], s55 offen offset:0 sc1
  ds_read_b128 v[120:123], v190 offset:256
  ds_read_b128 v[124:127], v190 offset:272
  ds_read_b128 v[128:131], v190 offset:320
  ds_read_b128 v[132:135], v190 offset:336
  v_mfma_f32_32x32x16_bf16 v[32:47], v[76:79], a[16:19], v[32:47]
  ds_read_b64_tr_b16 v[72:73], v9 offset:13312
  ds_read_b64_tr_b16 v[74:75], v9 offset:13568
  ds_read_b64_tr_b16 v[76:77], v8 offset:13312
  ds_read_b64_tr_b16 v[78:79], v8 offset:13568
  s_waitcnt vmcnt(7) lgkmcnt(12)
  v_mfma_f32_32x32x16_bf16 v[48:63], v[80:83], a[20:23], v[48:63]
  s_add_u32 s55, s91, 12288
  buffer_load_dwordx4 a[52:55], v2, s[48:51], s55 offen offset:1024 sc1
  v_mfma_f32_32x32x16_bf16 v[32:47], v[84:87], a[20:23], v[32:47]
  ds_read_b64_tr_b16 v[80:81], v9 offset:16384
  ds_read_b64_tr_b16 v[82:83], v9 offset:16640
  ds_read_b64_tr_b16 v[84:85], v8 offset:16384
  ds_read_b64_tr_b16 v[86:87], v8 offset:16640
  s_waitcnt vmcnt(7) lgkmcnt(12)
  v_mfma_f32_32x32x16_bf16 v[48:63], v[64:67], a[24:27], v[48:63]
  s_add_u32 s55, s91, 12288
  buffer_load_dwordx4 a[56:59], v2, s[48:51], s55 offen offset:2048 sc1
  ds_read_b128 v[136:139], v190 offset:512
  ds_read_b128 v[140:143], v190 offset:528
  ds_read_b128 v[144:147], v190 offset:576
  ds_read_b128 v[148:151], v190 offset:592
  v_mfma_f32_32x32x16_bf16 v[32:47], v[68:71], a[24:27], v[32:47]
  ds_read_b64_tr_b16 v[64:65], v9 offset:17408
  ds_read_b64_tr_b16 v[66:67], v9 offset:17664
  ds_read_b64_tr_b16 v[68:69], v8 offset:17408
  ds_read_b64_tr_b16 v[70:71], v8 offset:17664
  s_waitcnt vmcnt(7) lgkmcnt(12)
  v_mfma_f32_32x32x16_bf16 v[48:63], v[72:75], a[28:31], v[48:63]
  s_add_u32 s55, s91, 12288
  buffer_load_dwordx4 a[60:63], v2, s[48:51], s55 offen offset:3072 sc1
  v_mfma_f32_32x32x16_bf16 v[32:47], v[76:79], a[28:31], v[32:47]
  ds_read_b64_tr_b16 v[72:73], v9 offset:20480
  ds_read_b64_tr_b16 v[74:75], v9 offset:20736
  ds_read_b64_tr_b16 v[76:77], v8 offset:20480
  ds_read_b64_tr_b16 v[78:79], v8 offset:20736
  s_waitcnt vmcnt(7) lgkmcnt(12)
  v_mfma_f32_32x32x16_bf16 v[48:63], v[80:83], a[32:35], v[48:63]
  s_add_u32 s55, s90, 5
  s_and_b32 s55, s55, 7
  s_mul_i32 s55, s55, 176128
  s_add_u32 s55, s55, s89
  buffer_load_dwordx4 a[188:191], v245, s[28:31], s55 offen offset:0
  buffer_load_dwordx4 a[192:195], v245, s[28:31], s55 offen offset:64
  buffer_load_dwordx4 a[196:199], v245, s[28:31], s55 offen offset:128
  ds_read_b128 v[152:155], v190 offset:768
  ds_read_b128 v[156:159], v190 offset:784
  ds_read_b128 v[160:163], v190 offset:832
  ds_read_b128 v[164:167], v190 offset:848
  v_mfma_f32_32x32x16_bf16 v[32:47], v[84:87], a[32:35], v[32:47]
  ds_read_b64_tr_b16 v[80:81], v9 offset:21504
  ds_read_b64_tr_b16 v[82:83], v9 offset:21760
  ds_read_b64_tr_b16 v[84:85], v8 offset:21504
  ds_read_b64_tr_b16 v[86:87], v8 offset:21760
  s_waitcnt vmcnt(9) lgkmcnt(12)
  v_mfma_f32_32x32x16_bf16 v[48:63], v[64:67], a[36:39], v[48:63]
  s_lshl4_add_u32 s55, s58, s59
  s_lshl2_add_u32 s55, s55, s60
  s_lshl_b32 s55, s55, 9
  s_add_u32 s55, s55, 81920
  s_mov_b32 exec_hi, 0
  buffer_load_dword v255, v2, s[48:51], s55 offen sc1
  s_mov_b32 exec_hi, -1
  v_mfma_f32_32x32x16_bf16 v[32:47], v[68:71], a[36:39], v[32:47]
  ds_read_b64_tr_b16 v[64:65], v9 offset:24576
  ds_read_b64_tr_b16 v[66:67], v9 offset:24832
  ds_read_b64_tr_b16 v[68:69], v8 offset:24576
  ds_read_b64_tr_b16 v[70:71], v8 offset:24832
  s_waitcnt vmcnt(9) lgkmcnt(12)
  v_mfma_f32_32x32x16_bf16 v[48:63], v[72:75], a[40:43], v[48:63]
  v_mfma_f32_32x32x16_bf16 v[32:47], v[76:79], a[40:43], v[32:47]
  ds_read_b64_tr_b16 v[72:73], v9 offset:25600
  ds_read_b64_tr_b16 v[74:75], v9 offset:25856
  ds_read_b64_tr_b16 v[76:77], v8 offset:25600
  ds_read_b64_tr_b16 v[78:79], v8 offset:25856
  s_waitcnt vmcnt(8) lgkmcnt(8)
  v_mfma_f32_32x32x16_bf16 v[48:63], v[80:83], a[44:47], v[48:63]
  v_mfma_f32_32x32x16_bf16 v[32:47], v[84:87], a[44:47], v[32:47]
  ds_read_b64_tr_b16 v[80:81], v9 offset:28672
  ds_read_b64_tr_b16 v[82:83], v9 offset:28928
  ds_read_b64_tr_b16 v[84:85], v8 offset:28672
  ds_read_b64_tr_b16 v[86:87], v8 offset:28928
  s_waitcnt vmcnt(7) lgkmcnt(8)
  v_mfma_f32_32x32x16_bf16 v[48:63], v[64:67], a[48:51], v[48:63]
  v_mfma_f32_32x32x16_bf16 v[32:47], v[68:71], a[48:51], v[32:47]
  ds_read_b64_tr_b16 v[64:65], v9 offset:29696
  ds_read_b64_tr_b16 v[66:67], v9 offset:29952
  ds_read_b64_tr_b16 v[68:69], v8 offset:29696
  ds_read_b64_tr_b16 v[70:71], v8 offset:29952
  s_waitcnt vmcnt(6) lgkmcnt(8)
  v_mfma_f32_32x32x16_bf16 v[48:63], v[72:75], a[52:55], v[48:63]
  v_mfma_f32_32x32x16_bf16 v[32:47], v[76:79], a[52:55], v[32:47]
  s_waitcnt vmcnt(5) lgkmcnt(4)
  v_mfma_f32_32x32x16_bf16 v[48:63], v[80:83], a[56:59], v[48:63]
  v_mfma_f32_32x32x16_bf16 v[32:47], v[84:87], a[56:59], v[32:47]
  s_waitcnt vmcnt(4) lgkmcnt(0)
  v_mfma_f32_32x32x16_bf16 v[48:63], v[64:67], a[60:63], v[48:63]
  s_add_u32 s55, s90, 3
  s_and_b32 s55, s55, 7
  s_mul_i32 s55, s55, 176128
  s_add_u32 s55, s55, s89
  s_add_u32 m0, s54, 118784
  s_nop 0
  buffer_load_dwordx4 v245, s[28:31], s55 offen offset:0 lds
  s_add_u32 m0, s54, 126912
  s_nop 0
  buffer_load_dwordx4 v245, s[28:31], s55 offen offset:64 lds
  s_add_u32 m0, s54, 135040
  s_nop 0
  buffer_load_dwordx4 v245, s[28:31], s55 offen offset:128 lds
  v_mfma_f32_32x32x16_bf16 v[32:47], v[68:71], a[60:63], v[32:47]
  s_lshl_b32 s72, s60, 12
  s_xor_b32 s73, s72, 8192
  s_add_u32 s72, s72, 90112
  s_add_u32 s73, s73, 90112
  v_add_u32 v8, s72, v2
  v_add_u32 v9, s73, v2
  ds_write_b128 v8, v[48:51] offset:0
  ds_write_b128 v8, v[52:55] offset:1024
  ds_write_b128 v8, v[56:59] offset:2048
  ds_write_b128 v8, v[60:63] offset:3072
  s_lshl_b32 s72, s58, 15
  s_lshl_b32 s73, s76, 13
  s_add_u32 s72, s72, s73
  s_add_u32 s71, s72, 81920
  s_lshl_b32 s73, s77, 9
  s_add_u32 s72, s71, s73
  v_mov_b32 v66, s56
  v_mov_b32 v67, s56
  v_pk_fma_f32 v[16:17], v[32:33], v[104:105], v[16:17]
  v_pk_fma_f32 v[18:19], v[34:35], v[106:107], v[18:19]
  v_pk_fma_f32 v[20:21], v[36:37], v[108:109], v[20:21]
  v_pk_fma_f32 v[22:23], v[38:39], v[110:111], v[22:23]
  v_pk_fma_f32 v[24:25], v[40:41], v[112:113], v[24:25]
  v_pk_fma_f32 v[26:27], v[42:43], v[114:115], v[26:27]
  v_pk_fma_f32 v[28:29], v[44:45], v[116:117], v[28:29]
  v_pk_fma_f32 v[30:31], v[46:47], v[118:119], v[30:31]
  s_waitcnt lgkmcnt(0)
  s_barrier
  ds_read_b128 v[48:51], v9 offset:0
  ds_read_b128 v[52:55], v9 offset:1024
  ds_read_b128 v[56:59], v9 offset:2048
  ds_read_b128 v[60:63], v9 offset:3072
  s_waitcnt lgkmcnt(3)
  v_pk_fma_f32 v[16:17], v[48:49], v[104:105], v[16:17]
  v_pk_fma_f32 v[18:19], v[50:51], v[106:107], v[18:19]
  s_waitcnt lgkmcnt(2)
  v_pk_fma_f32 v[20:21], v[52:53], v[108:109], v[20:21]
  v_pk_fma_f32 v[22:23], v[54:55], v[110:111], v[22:23]
  s_waitcnt lgkmcnt(1)
  v_pk_fma_f32 v[24:25], v[56:57], v[112:113], v[24:25]
  v_pk_fma_f32 v[26:27], v[58:59], v[114:115], v[26:27]
  s_waitcnt lgkmcnt(0)
  v_pk_fma_f32 v[28:29], v[60:61], v[116:117], v[28:29]
  v_pk_fma_f32 v[30:31], v[62:63], v[118:119], v[30:31]
  v_pk_add_f32 v[32:33], v[16:17], v[18:19]
  v_pk_mul_f32 v[34:35], v[16:17], v[16:17]
  v_pk_fma_f32 v[34:35], v[18:19], v[18:19], v[34:35]
  v_pk_add_f32 v[32:33], v[32:33], v[20:21]
  v_pk_fma_f32 v[34:35], v[20:21], v[20:21], v[34:35]
  v_pk_add_f32 v[32:33], v[32:33], v[22:23]
  v_pk_fma_f32 v[34:35], v[22:23], v[22:23], v[34:35]
  v_pk_add_f32 v[32:33], v[32:33], v[24:25]
  v_pk_fma_f32 v[34:35], v[24:25], v[24:25], v[34:35]
  v_pk_add_f32 v[32:33], v[32:33], v[26:27]
  v_pk_fma_f32 v[34:35], v[26:27], v[26:27], v[34:35]
  v_pk_add_f32 v[32:33], v[32:33], v[28:29]
  v_pk_fma_f32 v[34:35], v[28:29], v[28:29], v[34:35]
  v_pk_add_f32 v[32:33], v[32:33], v[30:31]
  v_pk_fma_f32 v[34:35], v[30:31], v[30:31], v[34:35]
  v_add_f32 v64, v32, v33
  v_add_f32 v65, v34, v35
  v_add_f32 v68, v32, v33
  v_add_f32 v69, v34, v35
  s_nop 0
  v_permlane32_swap_b32 v68, v64
  v_permlane32_swap_b32 v69, v65
  v_add_f32 v64, v64, v68
  v_add_f32 v65, v65, v69
  s_mov_b32 exec_hi, 0
  s_cmp_eq_u32 s57, 0
  s_cbranch_scc1 L_47
  buffer_store_dwordx4 v[64:67], v2, s[48:51], s72 offen
  s_branch L_48
L_47:
  buffer_store_dwordx4 v[64:67], v2, s[48:51], s72 offen sc1
L_48:
  s_mov_b32 exec_hi, -1
  s_barrier
  v_add_u32 v240, s54, v2
  v_and_b32 v7, 31, v1
  v_add_u32 v241, 0x10000, v240
  v_lshlrev_b32 v7, 4, v7
  v_add_u32 v242, 0x20000, v240
  v_lshl_add_u32 v7, v3, 12, v7
  buffer_load_dword v255, v254, s[32:35], s95 offen
  s_add_u32 s95, s95, 16384
  s_cmp_eq_u32 s95, 98304
  s_cselect_b32 s95, 0, s95
  v_cvt_pk_bf16_f32 v232, v152, v153
  v_cvt_pk_bf16_f32 v233, v154, v155
  v_cvt_pk_bf16_f32 v234, v156, v157
  v_cvt_pk_bf16_f32 v235, v158, v159
  v_cvt_pk_bf16_f32 v236, v160, v161
  v_cvt_pk_bf16_f32 v237, v162, v163
  v_cvt_pk_bf16_f32 v238, v164, v165
  v_cvt_pk_bf16_f32 v239, v166, v167
  s_lshr_b32 s66, s52, 3
  s_and_b32 s67, s2, 0
  s_cmp_eq_u32 s60, 3
  s_cselect_b32 s69, 10, 99
  s_mov_b32 s4, 7750416
  s_cmp_eq_u32 s60, 1
  s_cselect_b32 s4, 8803104, s4
  s_cmp_eq_u32 s60, 2
  s_cselect_b32 s4, 8868897, s4
  s_cmp_eq_u32 s60, 3
  s_cselect_b32 s4, 7750416, s4
  s_mov_b32 s5, 0
  s_lshl_b64 s[6:7], s[4:5], 24
  s_or_b64 s[4:5], s[4:5], s[6:7]
  s_lshl_b32 s68, s66, 2
  s_lshr_b32 s68, 21280, s68
  s_and_b32 s68, s68, 15
  s_add_u32 s68, s68, s67
  s_sub_u32 s6, s68, 6
  s_cmp_ge_u32 s68, 6
  s_cselect_b32 s68, s6, s68
  s_sub_u32 s6, s68, 6
  s_cmp_ge_u32 s68, 6
  s_cselect_b32 s68, s6, s68
  s_lshl_b32 s68, s68, 2
  s_lshr_b64 s[4:5], s[4:5], s68
  s_bfe_u32 s82, s4, 262144
  s_lshl_b32 s82, s82, 15
  s_bfe_u32 s83, s4, 262148
  s_lshl_b32 s83, s83, 15
  s_bfe_u32 s84, s4, 262152
  s_lshl_b32 s84, s84, 15
  s_bfe_u32 s85, s4, 262156
  s_lshl_b32 s85, s85, 15
  s_bfe_u32 s86, s4, 262160
  s_lshl_b32 s86, s86, 15
  s_bfe_u32 s87, s4, 262164
  s_lshl_b32 s87, s87, 15
  s_mov_b32 s4, 694354
  s_cmp_eq_u32 s60, 1
  s_cselect_b32 s4, 632641, s4
  s_cmp_eq_u32 s60, 2
  s_cselect_b32 s4, 693808, s4
  s_cmp_eq_u32 s60, 3
  s_cselect_b32 s4, 632914, s4
  s_mov_b32 s5, 0
  s_lshl_b64 s[6:7], s[4:5], 20
  s_or_b64 s[4:5], s[4:5], s[6:7]
  s_lshl_b32 s68, s66, 2
  s_lshr_b32 s68, 12816, s68
  s_and_b32 s68, s68, 15
  s_add_u32 s68, s68, s67
  s_sub_u32 s6, s68, 5
  s_cmp_ge_u32 s68, 5
  s_cselect_b32 s68, s6, s68
  s_sub_u32 s6, s68, 5
  s_cmp_ge_u32 s68, 5
  s_cselect_b32 s68, s6, s68
  s_lshl_b32 s68, s68, 2
  s_lshr_b64 s[4:5], s[4:5], s68
  s_bfe_u32 s88, s4, 262144
  s_cmp_eq_u32 s88, s69
  s_cselect_b32 s88, 0x2000, s88
  s_lshl_b32 s88, s88, 15
  s_bfe_u32 s96, s4, 262148
  s_cmp_eq_u32 s96, s69
  s_cselect_b32 s96, 0x2000, s96
  s_lshl_b32 s96, s96, 15
  s_bfe_u32 s97, s4, 262152
  s_cmp_eq_u32 s97, s69
  s_cselect_b32 s97, 0x2000, s97
  s_lshl_b32 s97, s97, 15
  s_bfe_u32 s98, s4, 262156
  s_cmp_eq_u32 s98, s69
  s_cselect_b32 s98, 0x2000, s98
  s_lshl_b32 s98, s98, 15
  s_bfe_u32 s99, s4, 262160
  s_cmp_eq_u32 s99, s69
  s_cselect_b32 s99, 0x2000, s99
  s_lshl_b32 s99, s99, 15
  s_add_u32 s55, s90, 3
  s_and_b32 s55, s55, 7
  s_mul_i32 s55, s55, 176128
  s_add_u32 s55, s55, s89
  s_add_u32 m0, s54, 114688
  s_nop 0
  buffer_load_dwordx4 v244, s[24:27], s55 offen offset:0 lds
  s_add_u32 m0, s54, 122816
  s_nop 0
  buffer_load_dwordx4 v244, s[24:27], s55 offen offset:64 lds
  s_add_u32 m0, s54, 130944
  s_nop 0
  buffer_load_dwordx4 v244, s[24:27], s55 offen offset:128 lds
  buffer_load_dwordx4 v[32:35], v7, s[48:51], s71 offen offset:0 sc1
  buffer_load_dwordx4 v[36:39], v7, s[48:51], s71 offen offset:512 sc1
  buffer_load_dwordx4 v[40:43], v7, s[48:51], s71 offen offset:1024 sc1
  buffer_load_dwordx4 v[44:47], v7, s[48:51], s71 offen offset:1536 sc1
  buffer_load_dwordx4 v[48:51], v7, s[48:51], s71 offen offset:2048 sc1
  buffer_load_dwordx4 v[52:55], v7, s[48:51], s71 offen offset:2560 sc1
  buffer_load_dwordx4 v[56:59], v7, s[48:51], s71 offen offset:3072 sc1
  buffer_load_dwordx4 v[60:63], v7, s[48:51], s71 offen offset:3584 sc1
  s_waitcnt vmcnt(63)
  ds_write_b128 v240, a[128:131] offset:0
  ds_write_b128 v240, a[140:143] offset:4096
  ds_write_b128 v240, a[132:135] offset:8192
  ds_write_b128 v240, a[144:147] offset:12288
  ds_write_b128 v240, a[136:139] offset:16384
  ds_write_b128 v240, a[148:151] offset:20480
  s_waitcnt vmcnt(41)
  ds_write_b128 v240, a[152:155] offset:32768
  ds_write_b128 v240, a[164:167] offset:36864
  ds_write_b128 v240, a[156:159] offset:40960
  ds_write_b128 v240, a[168:171] offset:45056
  ds_write_b128 v240, a[160:163] offset:24576
  ds_write_b128 v240, a[172:175] offset:28672
  s_waitcnt vmcnt(17)
  ds_write_b128 v240, a[176:179] offset:49152
  ds_write_b128 v240, a[188:191] offset:53248
  ds_write_b128 v240, a[180:183] offset:57344
  ds_write_b128 v240, a[192:195] offset:61440
  ds_write_b128 v241, a[184:187] offset:24576
  ds_write_b128 v241, a[196:199] offset:28672
  buffer_load_dword v255, v254, s[32:35], s95 offen
  s_add_u32 s95, s95, 16384
  s_cmp_eq_u32 s95, 98304
  s_cselect_b32 s95, 0, s95
  buffer_load_dword v255, v254, s[32:35], s95 offen
  s_add_u32 s95, s95, 16384
  s_cmp_eq_u32 s95, 98304
  s_cselect_b32 s95, 0, s95
  s_mov_b32 s65, 0
  s_waitcnt vmcnt(2)
  v_min_u32 v64, v34, v38
  v_max_u32 v65, v34, v38
  v_min3_u32 v64, v64, v42, v46
  v_max3_u32 v65, v65, v42, v46
  v_min3_u32 v64, v64, v50, v54
  v_max3_u32 v65, v65, v50, v54
  v_min3_u32 v64, v64, v58, v62
  v_max3_u32 v65, v65, v58, v62
  v_xor_b32 v64, s56, v64
  v_xor_b32 v65, s56, v65
  v_or_b32 v64, v64, v65
  v_cmp_ne_u32 vcc, 0, v64
  s_cbranch_vccz PD_49
  s_mov_b32 s65, 0
P_50:
  buffer_load_dwordx4 v[32:35], v7, s[48:51], s71 offen offset:0 sc1
  buffer_load_dwordx4 v[36:39], v7, s[48:51], s71 offen offset:512 sc1
  buffer_load_dwordx4 v[40:43], v7, s[48:51], s71 offen offset:1024 sc1
  buffer_load_dwordx4 v[44:47], v7, s[48:51], s71 offen offset:1536 sc1
  buffer_load_dwordx4 v[48:51], v7, s[48:51], s71 offen offset:2048 sc1
  buffer_load_dwordx4 v[52:55], v7, s[48:51], s71 offen offset:2560 sc1
  buffer_load_dwordx4 v[56:59], v7, s[48:51], s71 offen offset:3072 sc1
  buffer_load_dwordx4 v[60:63], v7, s[48:51], s71 offen offset:3584 sc1
  s_add_u32 s65, s65, 1
  s_cmp_gt_u32 s65, 20000
  s_cbranch_scc1 PE_51
  s_waitcnt vmcnt(0)
  v_min_u32 v64, v34, v38
  v_max_u32 v65, v34, v38
  v_min3_u32 v64, v64, v42, v46
  v_max3_u32 v65, v65, v42, v46
  v_min3_u32 v64, v64, v50, v54
  v_max3_u32 v65, v65, v50, v54
  v_min3_u32 v64, v64, v58, v62
  v_max3_u32 v65, v65, v58, v62
  v_xor_b32 v64, s56, v64
  v_xor_b32 v65, s56, v65
  v_or_b32 v64, v64, v65
  v_cmp_ne_u32 vcc, 0, v64
  s_cbranch_vccnz P_50
PE_51:
  s_waitcnt vmcnt(0)
PD_49:
  v_pk_add_f32 v[32:33], v[32:33], v[48:49]
  v_pk_add_f32 v[36:37], v[36:37], v[52:53]
  v_pk_add_f32 v[40:41], v[40:41], v[56:57]
  v_pk_add_f32 v[44:45], v[44:45], v[60:61]
  v_pk_add_f32 v[32:33], v[32:33], v[36:37]
  v_pk_add_f32 v[40:41], v[40:41], v[44:45]
  v_pk_add_f32 v[34:35], v[32:33], v[40:41]
  v_pk_add_f32 v[32:33], v[32:33], v[40:41]
  s_lshl_b32 s72, s76, 15
  s_lshl_b32 s73, s77, 11
  v_permlane32_swap_b32 v34, v32
  v_permlane32_swap_b32 v35, v33
  v_add_f32 v32, v32, v34
  v_add_f32 v33, v33, v35
  v_mul_f32 v32, 0.001953125, v32
  v_mov_b32 v34, 0x3727c5ac
  v_fmac_f32 v34, 0.001953125, v33
  v_fma_f32 v33, -v32, v32, v34
  v_max_f32 v33, 0x3727c5ac, v33
  v_rsq_f32 v33, v33
  s_add_u32 s72, s72, s73
  s_add_u32 s72, s72, s63
  v_mul_f32 v32, v32, v33
  v_pk_fma_f32 v[48:49], v[16:17], v[32:33], v[32:33] op_sel:[0,1,0] op_sel_hi:[1,1,0] neg_lo:[0,0,1] neg_hi:[0,0,1]
  v_pk_fma_f32 v[50:51], v[18:19], v[32:33], v[32:33] op_sel:[0,1,0] op_sel_hi:[1,1,0] neg_lo:[0,0,1] neg_hi:[0,0,1]
  v_pk_fma_f32 v[52:53], v[20:21], v[32:33], v[32:33] op_sel:[0,1,0] op_sel_hi:[1,1,0] neg_lo:[0,0,1] neg_hi:[0,0,1]
  v_pk_fma_f32 v[54:55], v[22:23], v[32:33], v[32:33] op_sel:[0,1,0] op_sel_hi:[1,1,0] neg_lo:[0,0,1] neg_hi:[0,0,1]
  v_pk_fma_f32 v[56:57], v[24:25], v[32:33], v[32:33] op_sel:[0,1,0] op_sel_hi:[1,1,0] neg_lo:[0,0,1] neg_hi:[0,0,1]
  v_pk_fma_f32 v[58:59], v[26:27], v[32:33], v[32:33] op_sel:[0,1,0] op_sel_hi:[1,1,0] neg_lo:[0,0,1] neg_hi:[0,0,1]
  v_pk_fma_f32 v[60:61], v[28:29], v[32:33], v[32:33] op_sel:[0,1,0] op_sel_hi:[1,1,0] neg_lo:[0,0,1] neg_hi:[0,0,1]
  v_pk_fma_f32 v[62:63], v[30:31], v[32:33], v[32:33] op_sel:[0,1,0] op_sel_hi:[1,1,0] neg_lo:[0,0,1] neg_hi:[0,0,1]
  v_pk_fma_f32 v[48:49], v[48:49], v[136:137], v[120:121]
  v_pk_fma_f32 v[50:51], v[50:51], v[138:139], v[122:123]
  v_pk_fma_f32 v[52:53], v[52:53], v[140:141], v[124:125]
  v_pk_fma_f32 v[54:55], v[54:55], v[142:143], v[126:127]
  v_pk_fma_f32 v[56:57], v[56:57], v[144:145], v[128:129]
  v_pk_fma_f32 v[58:59], v[58:59], v[146:147], v[130:131]
  v_pk_fma_f32 v[60:61], v[60:61], v[148:149], v[132:133]
  v_pk_fma_f32 v[62:63], v[62:63], v[150:151], v[134:135]
  v_cvt_pk_bf16_f32 v48, v48, v49
  v_cvt_pk_bf16_f32 v49, v50, v51
  v_cvt_pk_bf16_f32 v50, v52, v53
  v_cvt_pk_bf16_f32 v51, v54, v55
  v_cvt_pk_bf16_f32 v52, v56, v57
  v_cvt_pk_bf16_f32 v53, v58, v59
  v_cvt_pk_bf16_f32 v54, v60, v61
  v_cvt_pk_bf16_f32 v55, v62, v63
  s_cmp_eq_u32 s57, 0
  s_cbranch_scc1 L_52
  buffer_store_dwordx4 v[48:51], v2, s[48:51], s72 offen nt
  buffer_store_dwordx4 v[52:55], v2, s[48:51], s72 offen offset:1024 nt
  s_branch L_53
L_52:
  buffer_store_dwordx4 v[48:51], v2, s[48:51], s72 offen sc1
  buffer_store_dwordx4 v[52:55], v2, s[48:51], s72 offen offset:1024 sc1
L_53:
  s_lshl_b32 s72, s76, 6
  s_lshl_b32 s73, s77, 2
  s_add_u32 s72, s72, s73
  s_add_u32 s72, s72, s62
  s_lshl_b32 s67, s60, 15
  s_add_u32 s91, s67, s63
  s_lshl_b32 s92, s90, 12
  s_lshl_b32 s94, s60, 13
  s_add_u32 s94, s94, s64
  s_mov_b32 s6, 0xffff0000
  s_mov_b32 s7, 0xffff0000
  v_and_b32 v14, 0xffffffdf, v5
  v_lshl_add_u32 v14, v3, 9, v14
  v_mov_b32 v7, 4128
  v_mov_b32 v8, 4096
  v_cndmask_b32 v7, 0, v7, s[6:7]
  v_cndmask_b32 v8, 32, v8, s[6:7]
  v_add_u32 v246, v7, v14
  v_add_u32 v247, v8, v14
  v_add_u32 v248, 0x10000, v246
  v_add_u32 v249, 0x10000, v247
  v_add_u32 v250, 0x20000, v246
  v_add_u32 v251, 0x20000, v247
  v_lshl_add_u32 v10, v3, 12, v5
  v_add_u32 v10, s54, v10
  s_lshl_b32 s66, s75, 9
  s_xor_b32 s67, s66, 512
  v_add_u32 v225, s67, v10
  v_add_u32 v224, s66, v10
  v_add_u32 v226, 0x10000, v224
  v_add_u32 v227, 0x10000, v225
  v_add_u32 v228, 0x20000, v224
  v_add_u32 v229, 0x20000, v225
  v_and_b32 v7, 15, v1
  v_lshlrev_b32 v7, 2, v7
  s_lshl_b32 s71, s60, 6
  s_add_u32 s71, s71, s62
  v_and_b32 v230, 15, v1
  v_min_u32 v230, 14, v230
  v_and_b32 v8, 16, v1
  v_add_u32 v230, v230, v8
  v_lshlrev_b32 v230, 2, v230
  s_and_b32 s70, s76, 2
  s_lshl_b32 s70, s70, 6
  s_add_u32 s70, s70, s62
  s_lshl_b32 s66, s76, 11
  s_xor_b32 s67, s66, 2048
  s_add_u32 s66, s66, s94
  s_add_u32 s67, s67, s94
  v_add_u32 v8, s66, v2
  v_add_u32 v9, s67, v2
  v_add_u32 v11, 8192, v13
  v_add_u32 v12, 16384, v13
  v_add_u32 v15, 24576, v13
  s_lshl_b32 s73, s59, 2
  s_add_u32 s73, s73, s71
  v_bfe_u32 v252, v1, 1, 4
  v_lshlrev_b32 v252, 7, v252
  v_lshl_add_u32 v252, v3, 13, v252
  v_lshrrev_b32 v253, 2, v1
  v_lshlrev_b32 v253, 7, v253
  v_mov_b32 v3, 0
  v_mov_b32 v4, s56
  s_waitcnt vmcnt(0)
  s_mov_b64 exec, 1
  s_cmp_eq_u32 s57, 0
  s_cbranch_scc1 L_54
  buffer_store_dword v4, v3, s[48:51], s72 offen offset:512
  s_branch L_55
L_54:
  buffer_store_dword v4, v3, s[48:51], s72 offen offset:512 sc1
L_55:
  s_mov_b64 exec, -1
  s_add_u32 s55, s90, 1
  s_and_b32 s55, s55, 7
  s_mul_i32 s55, s55, 176128
  s_add_u32 s55, s55, s89
  s_add_u32 m0, s54, 151552
  s_nop 0
  buffer_load_dwordx4 v245, s[28:31], s55 offen offset:0 lds
  s_add_u32 m0, s54, 159680
  s_nop 0
  buffer_load_dwordx4 v245, s[28:31], s55 offen offset:64 lds
  s_add_u32 m0, s54, 143232
  s_nop 0
  buffer_load_dwordx4 v245, s[28:31], s55 offen offset:128 lds
  s_cmp_lg_u32 s59, 15
  s_cbranch_scc1 L_g3
  s_waitcnt lgkmcnt(0)
  s_lshl2_add_u32 s69, s99, s93
  s_add_u32 m0, s54, 98304
  s_nop 0
  buffer_load_dwordx4 v12, s[32:35], s69 offen lds
  s_lshl2_add_u32 s69, s99, s93
  s_add_u32 m0, s54, 102400
  s_nop 0
  buffer_load_dwordx4 v15, s[32:35], s69 offen lds
  s_lshl2_add_u32 s69, s99, s93
  s_add_u32 m0, s54, 0
  s_nop 0
  buffer_load_dwordx4 v13, s[32:35], s69 offen lds
  s_lshl2_add_u32 s69, s99, s93
  s_add_u32 m0, s54, 4096
  s_nop 0
  buffer_load_dwordx4 v11, s[32:35], s69 offen lds
  s_lshl2_add_u32 s69, s98, s93
  s_add_u32 m0, s54, 8192
  s_nop 0
  buffer_load_dwordx4 v12, s[32:35], s69 offen lds
  s_lshl2_add_u32 s69, s98, s93
  s_add_u32 m0, s54, 12288
  s_nop 0
  buffer_load_dwordx4 v15, s[32:35], s69 offen lds
  s_waitcnt vmcnt(0)
  ds_read_b64_tr_b16 a[248:249], v226 offset:32768
  ds_read_b64_tr_b16 a[250:251], v226 offset:33024
  ds_read_b64_tr_b16 a[252:253], v227 offset:32768
  ds_read_b64_tr_b16 a[254:255], v227 offset:33024
  ds_read_b64_tr_b16 a[240:241], v224 offset:0
  ds_read_b64_tr_b16 a[242:243], v224 offset:256
  ds_read_b64_tr_b16 a[244:245], v225 offset:0
  ds_read_b64_tr_b16 a[246:247], v225 offset:256
  ds_read_b64_tr_b16 a[232:233], v224 offset:8192
  ds_read_b64_tr_b16 a[234:235], v224 offset:8448
  ds_read_b64_tr_b16 a[236:237], v225 offset:8192
  ds_read_b64_tr_b16 a[238:239], v225 offset:8448
  s_waitcnt lgkmcnt(0)
  s_lshl2_add_u32 s69, s98, s93
  s_add_u32 m0, s54, 98304
  s_nop 0
  buffer_load_dwordx4 v13, s[32:35], s69 offen lds
  s_lshl2_add_u32 s69, s98, s93
  s_add_u32 m0, s54, 102400
  s_nop 0
  buffer_load_dwordx4 v11, s[32:35], s69 offen lds
  s_lshl2_add_u32 s69, s97, s93
  s_add_u32 m0, s54, 0
  s_nop 0
  buffer_load_dwordx4 v12, s[32:35], s69 offen lds
  s_lshl2_add_u32 s69, s97, s93
  s_add_u32 m0, s54, 4096
  s_nop 0
  buffer_load_dwordx4 v15, s[32:35], s69 offen lds
  s_lshl2_add_u32 s69, s97, s93
  s_add_u32 m0, s54, 8192
  s_nop 0
  buffer_load_dwordx4 v13, s[32:35], s69 offen lds
  s_lshl2_add_u32 s69, s97, s93
  s_add_u32 m0, s54, 12288
  s_nop 0
  buffer_load_dwordx4 v11, s[32:35], s69 offen lds
  s_waitcnt vmcnt(0)
  ds_read_b64_tr_b16 a[224:225], v226 offset:32768
  ds_read_b64_tr_b16 a[226:227], v226 offset:33024
  ds_read_b64_tr_b16 a[228:229], v227 offset:32768
  ds_read_b64_tr_b16 a[230:231], v227 offset:33024
  ds_read_b64_tr_b16 a[216:217], v224 offset:0
  ds_read_b64_tr_b16 a[218:219], v224 offset:256
  ds_read_b64_tr_b16 a[220:221], v225 offset:0
  ds_read_b64_tr_b16 a[222:223], v225 offset:256
  ds_read_b64_tr_b16 a[208:209], v224 offset:8192
  ds_read_b64_tr_b16 a[210:211], v224 offset:8448
  ds_read_b64_tr_b16 a[212:213], v225 offset:8192
  ds_read_b64_tr_b16 a[214:215], v225 offset:8448
  s_waitcnt lgkmcnt(0)
  s_lshl2_add_u32 s69, s96, s93
  s_add_u32 m0, s54, 98304
  s_nop 0
  buffer_load_dwordx4 v12, s[32:35], s69 offen lds
  s_lshl2_add_u32 s69, s96, s93
  s_add_u32 m0, s54, 102400
  s_nop 0
  buffer_load_dwordx4 v15, s[32:35], s69 offen lds
  s_lshl2_add_u32 s69, s96, s93
  s_add_u32 m0, s54, 0
  s_nop 0
  buffer_load_dwordx4 v13, s[32:35], s69 offen lds
  s_lshl2_add_u32 s69, s96, s93
  s_add_u32 m0, s54, 4096
  s_nop 0
  buffer_load_dwordx4 v11, s[32:35], s69 offen lds
  s_lshl2_add_u32 s69, s88, s93
  s_add_u32 m0, s54, 8192
  s_nop 0
  buffer_load_dwordx4 v12, s[32:35], s69 offen lds
  s_lshl2_add_u32 s69, s88, s93
  s_add_u32 m0, s54, 12288
  s_nop 0
  buffer_load_dwordx4 v15, s[32:35], s69 offen lds
  s_waitcnt vmcnt(0)
  ds_read_b64_tr_b16 a[200:201], v226 offset:32768
  ds_read_b64_tr_b16 a[202:203], v226 offset:33024
  ds_read_b64_tr_b16 a[204:205], v227 offset:32768
  ds_read_b64_tr_b16 a[206:207], v227 offset:33024
  ds_read_b64_tr_b16 a[192:193], v224 offset:0
  ds_read_b64_tr_b16 a[194:195], v224 offset:256
  ds_read_b64_tr_b16 a[196:197], v225 offset:0
  ds_read_b64_tr_b16 a[198:199], v225 offset:256
  ds_read_b64_tr_b16 a[184:185], v224 offset:8192
  ds_read_b64_tr_b16 a[186:187], v224 offset:8448
  ds_read_b64_tr_b16 a[188:189], v225 offset:8192
  ds_read_b64_tr_b16 a[190:191], v225 offset:8448
  s_waitcnt lgkmcnt(0)
  s_lshl2_add_u32 s69, s88, s93
  s_add_u32 m0, s54, 98304
  s_nop 0
  buffer_load_dwordx4 v13, s[32:35], s69 offen lds
  s_lshl2_add_u32 s69, s88, s93
  s_add_u32 m0, s54, 102400
  s_nop 0
  buffer_load_dwordx4 v11, s[32:35], s69 offen lds
  s_lshl2_add_u32 s69, s87, s93
  s_add_u32 m0, s54, 0
  s_nop 0
  buffer_load_dwordx4 v12, s[32:35], s69 offen lds
  s_lshl2_add_u32 s69, s87, s93
  s_add_u32 m0, s54, 4096
  s_nop 0
  buffer_load_dwordx4 v15, s[32:35], s69 offen lds
  s_lshl2_add_u32 s69, s87, s93
  s_add_u32 m0, s54, 8192
  s_nop 0
  buffer_load_dwordx4 v13, s[32:35], s69 offen lds
  s_lshl2_add_u32 s69, s87, s93
  s_add_u32 m0, s54, 12288
  s_nop 0
  buffer_load_dwordx4 v11, s[32:35], s69 offen lds
  s_waitcnt vmcnt(0)
  ds_read_b64_tr_b16 a[176:177], v226 offset:32768
  ds_read_b64_tr_b16 a[178:179], v226 offset:33024
  ds_read_b64_tr_b16 a[180:181], v227 offset:32768
  ds_read_b64_tr_b16 a[182:183], v227 offset:33024
  ds_read_b64_tr_b16 a[168:169], v224 offset:0
  ds_read_b64_tr_b16 a[170:171], v224 offset:256
  ds_read_b64_tr_b16 a[172:173], v225 offset:0
  ds_read_b64_tr_b16 a[174:175], v225 offset:256
  s_waitcnt lgkmcnt(0)
  s_lshl2_add_u32 s69, s86, s93
  s_add_u32 m0, s54, 98304
  s_nop 0
  buffer_load_dwordx4 v12, s[32:35], s69 offen lds
  s_lshl2_add_u32 s69, s86, s93
  s_add_u32 m0, s54, 102400
  s_nop 0
  buffer_load_dwordx4 v15, s[32:35], s69 offen lds
  s_lshl2_add_u32 s69, s86, s93
  s_add_u32 m0, s54, 0
  s_nop 0
  buffer_load_dwordx4 v13, s[32:35], s69 offen lds
  s_lshl2_add_u32 s69, s86, s93
  s_add_u32 m0, s54, 4096
  s_nop 0
  buffer_load_dwordx4 v11, s[32:35], s69 offen lds
  s_waitcnt vmcnt(0)
  s_waitcnt lgkmcnt(0)
  s_lshl2_add_u32 s67, s82, s93
  s_add_u32 m0, s54, 32768
  s_nop 0
  buffer_load_dwordx4 v13, s[32:35], s67 offen lds
  s_lshl2_add_u32 s67, s82, s93
  s_add_u32 m0, s54, 36864
  s_nop 0
  buffer_load_dwordx4 v11, s[32:35], s67 offen lds
  s_lshl2_add_u32 s67, s82, s93
  s_add_u32 m0, s54, 40960
  s_nop 0
  buffer_load_dwordx4 v12, s[32:35], s67 offen lds
  s_lshl2_add_u32 s67, s82, s93
  s_add_u32 m0, s54, 45056
  s_nop 0
  buffer_load_dwordx4 v15, s[32:35], s67 offen lds
  s_lshl2_add_u32 s67, s83, s93
  s_add_u32 m0, s54, 49152
  s_nop 0
  buffer_load_dwordx4 v13, s[32:35], s67 offen lds
  s_lshl2_add_u32 s67, s83, s93
  s_add_u32 m0, s54, 53248
  s_nop 0
  buffer_load_dwordx4 v11, s[32:35], s67 offen lds
  s_lshl2_add_u32 s67, s83, s93
  s_add_u32 m0, s54, 57344
  s_nop 0
  buffer_load_dwordx4 v12, s[32:35], s67 offen lds
  s_lshl2_add_u32 s67, s83, s93
  s_add_u32 m0, s54, 61440
  s_nop 0
  buffer_load_dwordx4 v15, s[32:35], s67 offen lds
  s_lshl2_add_u32 s67, s84, s93
  s_add_u32 m0, s54, 147456
  s_nop 0
  buffer_load_dwordx4 v13, s[32:35], s67 offen lds
  s_lshl2_add_u32 s67, s84, s93
  s_add_u32 m0, s54, 151552
  s_nop 0
  buffer_load_dwordx4 v11, s[32:35], s67 offen lds
  s_lshl2_add_u32 s67, s84, s93
  s_add_u32 m0, s54, 155648
  s_nop 0
  buffer_load_dwordx4 v12, s[32:35], s67 offen lds
  s_lshl2_add_u32 s67, s84, s93
  s_add_u32 m0, s54, 159744
  s_nop 0
  buffer_load_dwordx4 v15, s[32:35], s67 offen lds
  s_lshl2_add_u32 s67, s85, s93
  s_add_u32 m0, s54, 73728
  s_nop 0
  buffer_load_dwordx4 v13, s[32:35], s67 offen lds
  s_lshl2_add_u32 s67, s85, s93
  s_add_u32 m0, s54, 77824
  s_nop 0
  buffer_load_dwordx4 v11, s[32:35], s67 offen lds
  s_lshl2_add_u32 s67, s85, s93
  s_add_u32 m0, s54, 114688
  s_nop 0
  buffer_load_dwordx4 v12, s[32:35], s67 offen lds
  s_lshl2_add_u32 s67, s85, s93
  s_add_u32 m0, s54, 118784
  s_nop 0
  buffer_load_dwordx4 v15, s[32:35], s67 offen lds
  s_mov_b32 s65, 0
P_56:
  buffer_load_dword v231, v230, s[48:51], s70 offen offset:1024 sc1
  s_add_u32 s65, s65, 1
  s_cmp_gt_u32 s65, 20000
  s_cbranch_scc1 PE_57
  s_waitcnt vmcnt(0)
  v_cmp_ne_u32 vcc, s56, v231
  s_cbranch_vccnz P_56
PE_57:
  s_waitcnt vmcnt(0)
  buffer_load_dwordx4 v[160:163], v8, s[48:51], s82 offen offset:0 sc1
  buffer_load_dwordx4 v[164:167], v9, s[48:51], s82 offen offset:0 sc1
  buffer_load_dwordx4 v[168:171], v8, s[48:51], s82 offen offset:1024 sc1
  buffer_load_dwordx4 v[172:175], v9, s[48:51], s82 offen offset:1024 sc1
  buffer_load_dwordx4 v[176:179], v8, s[48:51], s83 offen offset:0 sc1
  buffer_load_dwordx4 v[180:183], v9, s[48:51], s83 offen offset:0 sc1
  buffer_load_dwordx4 v[184:187], v8, s[48:51], s83 offen offset:1024 sc1
  buffer_load_dwordx4 v[188:191], v9, s[48:51], s83 offen offset:1024 sc1
  buffer_load_dwordx4 v[192:195], v8, s[48:51], s84 offen offset:0 sc1
  buffer_load_dwordx4 v[196:199], v9, s[48:51], s84 offen offset:0 sc1
  s_waitcnt vmcnt(0)
  s_branch L_g4
L_g3:
  s_mov_b32 s65, 0
P_58:
  buffer_load_dword v4, v7, s[48:51], s71 offen offset:512 sc1
  s_add_u32 s65, s65, 1
  s_cmp_gt_u32 s65, 20000
  s_cbranch_scc1 PE_59
  s_waitcnt vmcnt(0)
  v_cmp_ne_u32 vcc, s56, v4
  s_cbranch_vccnz P_58
PE_59:
  s_waitcnt vmcnt(0)
  s_add_u32 s68, s92, 0
  s_and_b32 s68, s68, 0x7000
  s_add_u32 s68, s68, s91
  buffer_load_dwordx4 a[0:3], v2, s[48:51], s68 offen offset:0 sc1
  buffer_load_dwordx4 a[4:7], v2, s[48:51], s68 offen offset:1024 sc1
  buffer_load_dwordx4 a[8:11], v2, s[48:51], s68 offen offset:2048 sc1
  buffer_load_dwordx4 a[12:15], v2, s[48:51], s68 offen offset:3072 sc1
  s_add_u32 s68, s92, 4096
  s_and_b32 s68, s68, 0x7000
  s_add_u32 s68, s68, s91
  buffer_load_dwordx4 a[16:19], v2, s[48:51], s68 offen offset:0 sc1
  buffer_load_dwordx4 a[20:23], v2, s[48:51], s68 offen offset:1024 sc1
  s_waitcnt lgkmcnt(0)
  s_barrier
  s_mul_i32 s72, s59, 24576
  s_min_u32 s72, s72, 327680
  s_lshl_b32 s66, s60, 11
  s_add_u32 s72, s72, s66
  s_add_u32 s72, s72, s64
  ds_read_b64_tr_b16 v[128:129], v246 offset:0
  ds_read_b64_tr_b16 v[130:131], v246 offset:256
  ds_read_b64_tr_b16 v[132:133], v247 offset:0
  ds_read_b64_tr_b16 v[134:135], v247 offset:256
  ds_read_b64_tr_b16 v[136:137], v246 offset:8192
  ds_read_b64_tr_b16 v[138:139], v246 offset:8448
  ds_read_b64_tr_b16 v[140:141], v247 offset:8192
  ds_read_b64_tr_b16 v[142:143], v247 offset:8448
  ds_read_b64_tr_b16 v[144:145], v246 offset:1024
  ds_read_b64_tr_b16 v[146:147], v246 offset:1280
  ds_read_b64_tr_b16 v[148:149], v247 offset:1024
  ds_read_b64_tr_b16 v[150:151], v247 offset:1280
  ds_read_b64_tr_b16 v[152:153], v246 offset:9216
  ds_read_b64_tr_b16 v[154:155], v246 offset:9472
  s_waitcnt vmcnt(5) lgkmcnt(8)
  v_mfma_f32_32x32x16_bf16 v[32:47], v[128:131], a[0:3], 0
  ds_read_b64_tr_b16 v[156:157], v247 offset:9216
  ds_read_b64_tr_b16 v[158:159], v247 offset:9472
  v_mfma_f32_32x32x16_bf16 v[48:63], v[132:135], a[0:3], 0
  buffer_load_dwordx4 a[24:27], v2, s[48:51], s68 offen offset:2048 sc1
  ds_read_b64_tr_b16 v[128:129], v246 offset:2048
  ds_read_b64_tr_b16 v[130:131], v246 offset:2304
  v_mfma_f32_32x32x16_bf16 v[64:79], v[136:139], a[0:3], 0
  ds_read_b64_tr_b16 v[132:133], v247 offset:2048
  ds_read_b64_tr_b16 v[134:135], v247 offset:2304
  s_waitcnt vmcnt(5) lgkmcnt(8)
  v_mfma_f32_32x32x16_bf16 v[80:95], v[140:143], a[0:3], 0
  buffer_load_dwordx4 a[28:31], v2, s[48:51], s68 offen offset:3072 sc1
  ds_read_b64_tr_b16 v[136:137], v246 offset:10240
  ds_read_b64_tr_b16 v[138:139], v246 offset:10496
  v_mfma_f32_32x32x16_bf16 v[32:47], v[144:147], a[4:7], v[32:47]
  ds_read_b64_tr_b16 v[140:141], v247 offset:10240
  ds_read_b64_tr_b16 v[142:143], v247 offset:10496
  v_mfma_f32_32x32x16_bf16 v[48:63], v[148:151], a[4:7], v[48:63]
  s_add_u32 s68, s92, 8192
  s_and_b32 s68, s68, 0x7000
  s_add_u32 s68, s68, s91
  buffer_load_dwordx4 a[32:35], v2, s[48:51], s68 offen offset:0 sc1
  ds_read_b64_tr_b16 v[144:145], v246 offset:3072
  ds_read_b64_tr_b16 v[146:147], v246 offset:3328
  s_waitcnt vmcnt(6) lgkmcnt(8)
  v_mfma_f32_32x32x16_bf16 v[64:79], v[152:155], a[4:7], v[64:79]
  ds_read_b64_tr_b16 v[148:149], v247 offset:3072
  ds_read_b64_tr_b16 v[150:151], v247 offset:3328
  v_mfma_f32_32x32x16_bf16 v[80:95], v[156:159], a[4:7], v[80:95]
  buffer_load_dwordx4 a[36:39], v2, s[48:51], s68 offen offset:1024 sc1
  ds_read_b64_tr_b16 v[152:153], v246 offset:11264
  ds_read_b64_tr_b16 v[154:155], v246 offset:11520
  v_mfma_f32_32x32x16_bf16 v[32:47], v[128:131], a[8:11], v[32:47]
  ds_read_b64_tr_b16 v[156:157], v247 offset:11264
  ds_read_b64_tr_b16 v[158:159], v247 offset:11520
  s_waitcnt lgkmcnt(8)
  v_mfma_f32_32x32x16_bf16 v[48:63], v[132:135], a[8:11], v[48:63]
  buffer_load_dwordx4 a[40:43], v2, s[48:51], s68 offen offset:2048 sc1
  ds_read_b64_tr_b16 v[128:129], v250 offset:16384
  ds_read_b64_tr_b16 v[130:131], v250 offset:16640
  v_mfma_f32_32x32x16_bf16 v[64:79], v[136:139], a[8:11], v[64:79]
  ds_read_b64_tr_b16 v[132:133], v251 offset:16384
  ds_read_b64_tr_b16 v[134:135], v251 offset:16640
  v_mfma_f32_32x32x16_bf16 v[80:95], v[140:143], a[8:11], v[80:95]
  buffer_load_dwordx4 a[44:47], v2, s[48:51], s68 offen offset:3072 sc1
  ds_read_b64_tr_b16 v[136:137], v250 offset:24576
  ds_read_b64_tr_b16 v[138:139], v250 offset:24832
  s_waitcnt vmcnt(8) lgkmcnt(8)
  v_mfma_f32_32x32x16_bf16 v[32:47], v[144:147], a[12:15], v[32:47]
  ds_read_b64_tr_b16 v[140:141], v251 offset:24576
  ds_read_b64_tr_b16 v[142:143], v251 offset:24832
  v_mfma_f32_32x32x16_bf16 v[48:63], v[148:151], a[12:15], v[48:63]
  s_add_u32 s68, s92, 12288
  s_and_b32 s68, s68, 0x7000
  s_add_u32 s68, s68, s91
  buffer_load_dwordx4 a[48:51], v2, s[48:51], s68 offen offset:0 sc1
  ds_read_b64_tr_b16 v[144:145], v250 offset:17408
  ds_read_b64_tr_b16 v[146:147], v250 offset:17664
  v_mfma_f32_32x32x16_bf16 v[64:79], v[152:155], a[12:15], v[64:79]
  ds_read_b64_tr_b16 v[148:149], v251 offset:17408
  ds_read_b64_tr_b16 v[150:151], v251 offset:17664
  s_waitcnt vmcnt(8) lgkmcnt(8)
  v_mfma_f32_32x32x16_bf16 v[80:95], v[156:159], a[12:15], v[80:95]
  buffer_load_dwordx4 a[52:55], v2, s[48:51], s68 offen offset:1024 sc1
  ds_read_b64_tr_b16 v[152:153], v250 offset:25600
  ds_read_b64_tr_b16 v[154:155], v250 offset:25856
  v_mfma_f32_32x32x16_bf16 v[32:47], v[128:131], a[16:19], v[32:47]
  s_barrier
  ds_read_b64_tr_b16 v[156:157], v251 offset:25600
  ds_read_b64_tr_b16 v[158:159], v251 offset:25856
  v_mfma_f32_32x32x16_bf16 v[48:63], v[132:135], a[16:19], v[48:63]
  buffer_load_dwordx4 a[56:59], v2, s[48:51], s68 offen offset:2048 sc1
  ds_read_b64_tr_b16 v[128:129], v250 offset:18432
  ds_read_b64_tr_b16 v[130:131], v250 offset:18688
  s_waitcnt vmcnt(9) lgkmcnt(8)
  v_mfma_f32_32x32x16_bf16 v[64:79], v[136:139], a[16:19], v[64:79]
  ds_read_b64_tr_b16 v[132:133], v251 offset:18432
  ds_read_b64_tr_b16 v[134:135], v251 offset:18688
  v_mfma_f32_32x32x16_bf16 v[80:95], v[140:143], a[16:19], v[80:95]
  buffer_load_dwordx4 a[60:63], v2, s[48:51], s68 offen offset:3072 sc1
  ds_read_b64_tr_b16 v[136:137], v250 offset:26624
  ds_read_b64_tr_b16 v[138:139], v250 offset:26880
  v_mfma_f32_32x32x16_bf16 v[32:47], v[144:147], a[20:23], v[32:47]
  ds_read_b64_tr_b16 v[140:141], v251 offset:26624
  ds_read_b64_tr_b16 v[142:143], v251 offset:26880
  s_waitcnt lgkmcnt(8)
  v_mfma_f32_32x32x16_bf16 v[48:63], v[148:151], a[20:23], v[48:63]
  s_add_u32 s68, s92, 16384
  s_and_b32 s68, s68, 0x7000
  s_add_u32 s68, s68, s91
  buffer_load_dwordx4 a[64:67], v2, s[48:51], s68 offen offset:0 sc1
  ds_read_b64_tr_b16 v[144:145], v250 offset:19456
  ds_read_b64_tr_b16 v[146:147], v250 offset:19712
  v_mfma_f32_32x32x16_bf16 v[64:79], v[152:155], a[20:23], v[64:79]
  ds_read_b64_tr_b16 v[148:149], v251 offset:19456
  ds_read_b64_tr_b16 v[150:151], v251 offset:19712
  v_mfma_f32_32x32x16_bf16 v[80:95], v[156:159], a[20:23], v[80:95]
  buffer_load_dwordx4 a[68:71], v2, s[48:51], s68 offen offset:1024 sc1
  ds_read_b64_tr_b16 v[152:153], v250 offset:27648
  ds_read_b64_tr_b16 v[154:155], v250 offset:27904
  s_waitcnt vmcnt(11) lgkmcnt(8)
  v_mfma_f32_32x32x16_bf16 v[32:47], v[128:131], a[24:27], v[32:47]
  ds_read_b64_tr_b16 v[156:157], v251 offset:27648
  ds_read_b64_tr_b16 v[158:159], v251 offset:27904
  v_mfma_f32_32x32x16_bf16 v[48:63], v[132:135], a[24:27], v[48:63]
  buffer_load_dwordx4 a[72:75], v2, s[48:51], s68 offen offset:2048 sc1
  ds_read_b64_tr_b16 v[128:129], v248 offset:0
  ds_read_b64_tr_b16 v[130:131], v248 offset:256
  v_mfma_f32_32x32x16_bf16 v[64:79], v[136:139], a[24:27], v[64:79]
  ds_read_b64_tr_b16 v[132:133], v249 offset:0
  ds_read_b64_tr_b16 v[134:135], v249 offset:256
  s_waitcnt vmcnt(11) lgkmcnt(8)
  v_mfma_f32_32x32x16_bf16 v[80:95], v[140:143], a[24:27], v[80:95]
  buffer_load_dwordx4 a[76:79], v2, s[48:51], s68 offen offset:3072 sc1
  ds_read_b64_tr_b16 v[136:137], v248 offset:8192
  ds_read_b64_tr_b16 v[138:139], v248 offset:8448
  v_mfma_f32_32x32x16_bf16 v[32:47], v[144:147], a[28:31], v[32:47]
  ds_read_b64_tr_b16 v[140:141], v249 offset:8192
  ds_read_b64_tr_b16 v[142:143], v249 offset:8448
  v_mfma_f32_32x32x16_bf16 v[48:63], v[148:151], a[28:31], v[48:63]
  s_add_u32 s68, s92, 20480
  s_and_b32 s68, s68, 0x7000
  s_add_u32 s68, s68, s91
  buffer_load_dwordx4 a[80:83], v2, s[48:51], s68 offen offset:0 sc1
  ds_read_b64_tr_b16 v[144:145], v248 offset:1024
  ds_read_b64_tr_b16 v[146:147], v248 offset:1280
  s_waitcnt vmcnt(12) lgkmcnt(8)
  v_mfma_f32_32x32x16_bf16 v[64:79], v[152:155], a[28:31], v[64:79]
  ds_read_b64_tr_b16 v[148:149], v249 offset:1024
  ds_read_b64_tr_b16 v[150:151], v249 offset:1280
  v_mfma_f32_32x32x16_bf16 v[80:95], v[156:159], a[28:31], v[80:95]
  buffer_load_dwordx4 a[84:87], v2, s[48:51], s68 offen offset:1024 sc1
  ds_read_b64_tr_b16 v[152:153], v248 offset:9216
  ds_read_b64_tr_b16 v[154:155], v248 offset:9472
  v_mfma_f32_32x32x16_bf16 v[32:47], v[128:131], a[32:35], v[32:47]
  ds_read_b64_tr_b16 v[156:157], v249 offset:9216
  ds_read_b64_tr_b16 v[158:159], v249 offset:9472
  s_waitcnt lgkmcnt(8)
  v_mfma_f32_32x32x16_bf16 v[48:63], v[132:135], a[32:35], v[48:63]
  buffer_load_dwordx4 a[88:91], v2, s[48:51], s68 offen offset:2048 sc1
  ds_read_b64_tr_b16 v[128:129], v248 offset:2048
  ds_read_b64_tr_b16 v[130:131], v248 offset:2304
  v_mfma_f32_32x32x16_bf16 v[64:79], v[136:139], a[32:35], v[64:79]
  ds_read_b64_tr_b16 v[132:133], v249 offset:2048
  ds_read_b64_tr_b16 v[134:135], v249 offset:2304
  v_mfma_f32_32x32x16_bf16 v[80:95], v[140:143], a[32:35], v[80:95]
  buffer_load_dwordx4 a[92:95], v2, s[48:51], s68 offen offset:3072 sc1
  ds_read_b64_tr_b16 v[136:137], v248 offset:10240
  ds_read_b64_tr_b16 v[138:139], v248 offset:10496
  s_waitcnt vmcnt(14) lgkmcnt(8)
  v_mfma_f32_32x32x16_bf16 v[32:47], v[144:147], a[36:39], v[32:47]
  ds_read_b64_tr_b16 v[140:141], v249 offset:10240
  ds_read_b64_tr_b16 v[142:143], v249 offset:10496
  v_mfma_f32_32x32x16_bf16 v[48:63], v[148:151], a[36:39], v[48:63]
  s_add_u32 s68, s92, 24576
  s_and_b32 s68, s68, 0x7000
  s_add_u32 s68, s68, s91
  buffer_load_dwordx4 a[96:99], v2, s[48:51], s68 offen offset:0 sc1
  ds_read_b64_tr_b16 v[144:145], v248 offset:3072
  ds_read_b64_tr_b16 v[146:147], v248 offset:3328
  v_mfma_f32_32x32x16_bf16 v[64:79], v[152:155], a[36:39], v[64:79]
  ds_read_b64_tr_b16 v[148:149], v249 offset:3072
  ds_read_b64_tr_b16 v[150:151], v249 offset:3328
  s_waitcnt vmcnt(14) lgkmcnt(8)
  v_mfma_f32_32x32x16_bf16 v[80:95], v[156:159], a[36:39], v[80:95]
  buffer_load_dwordx4 a[100:103], v2, s[48:51], s68 offen offset:1024 sc1
  ds_read_b64_tr_b16 v[152:153], v248 offset:11264
  ds_read_b64_tr_b16 v[154:155], v248 offset:11520
  v_mfma_f32_32x32x16_bf16 v[32:47], v[128:131], a[40:43], v[32:47]
  ds_read_b64_tr_b16 v[156:157], v249 offset:11264
  ds_read_b64_tr_b16 v[158:159], v249 offset:11520
  v_mfma_f32_32x32x16_bf16 v[48:63], v[132:135], a[40:43], v[48:63]
  buffer_load_dwordx4 a[104:107], v2, s[48:51], s68 offen offset:2048 sc1
  ds_read_b64_tr_b16 v[128:129], v248 offset:49152
  ds_read_b64_tr_b16 v[130:131], v248 offset:49408
  s_waitcnt vmcnt(15) lgkmcnt(8)
  v_mfma_f32_32x32x16_bf16 v[64:79], v[136:139], a[40:43], v[64:79]
  ds_read_b64_tr_b16 v[132:133], v249 offset:49152
  ds_read_b64_tr_b16 v[134:135], v249 offset:49408
  v_mfma_f32_32x32x16_bf16 v[80:95], v[140:143], a[40:43], v[80:95]
  buffer_load_dwordx4 a[108:111], v2, s[48:51], s68 offen offset:3072 sc1
  ds_read_b64_tr_b16 v[136:137], v248 offset:57344
  ds_read_b64_tr_b16 v[138:139], v248 offset:57600
  v_mfma_f32_32x32x16_bf16 v[32:47], v[144:147], a[44:47], v[32:47]
  ds_read_b64_tr_b16 v[140:141], v249 offset:57344
  ds_read_b64_tr_b16 v[142:143], v249 offset:57600
  s_waitcnt lgkmcnt(8)
  v_mfma_f32_32x32x16_bf16 v[48:63], v[148:151], a[44:47], v[48:63]
  s_add_u32 s68, s92, 28672
  s_and_b32 s68, s68, 0x7000
  s_add_u32 s68, s68, s91
  buffer_load_dwordx4 a[112:115], v2, s[48:51], s68 offen offset:0 sc1
  ds_read_b64_tr_b16 v[144:145], v248 offset:50176
  ds_read_b64_tr_b16 v[146:147], v248 offset:50432
  v_mfma_f32_32x32x16_bf16 v[64:79], v[152:155], a[44:47], v[64:79]
  ds_read_b64_tr_b16 v[148:149], v249 offset:50176
  ds_read_b64_tr_b16 v[150:151], v249 offset:50432
  v_mfma_f32_32x32x16_bf16 v[80:95], v[156:159], a[44:47], v[80:95]
  buffer_load_dwordx4 a[116:119], v2, s[48:51], s68 offen offset:1024 sc1
  ds_read_b64_tr_b16 v[152:153], v248 offset:58368
  ds_read_b64_tr_b16 v[154:155], v248 offset:58624
  s_waitcnt vmcnt(17) lgkmcnt(8)
  v_mfma_f32_32x32x16_bf16 v[32:47], v[128:131], a[48:51], v[32:47]
  s_barrier
  ds_read_b64_tr_b16 v[156:157], v249 offset:58368
  ds_read_b64_tr_b16 v[158:159], v249 offset:58624
  v_mfma_f32_32x32x16_bf16 v[48:63], v[132:135], a[48:51], v[48:63]
  s_add_u32 s55, s90, 6
  s_and_b32 s55, s55, 7
  s_mul_i32 s55, s55, 176128
  s_add_u32 s55, s55, s89
  s_add_u32 m0, s54, 151552
  s_nop 0
  buffer_load_dwordx4 v245, s[28:31], s55 offen offset:0 lds
  s_add_u32 m0, s54, 159680
  s_nop 0
  buffer_load_dwordx4 v245, s[28:31], s55 offen offset:64 lds
  s_add_u32 m0, s54, 69504
  s_nop 0
  buffer_load_dwordx4 v245, s[28:31], s55 offen offset:128 lds
  buffer_load_dwordx4 a[120:123], v2, s[48:51], s68 offen offset:2048 sc1
  ds_read_b64_tr_b16 v[128:129], v248 offset:51200
  ds_read_b64_tr_b16 v[130:131], v248 offset:51456
  v_mfma_f32_32x32x16_bf16 v[64:79], v[136:139], a[48:51], v[64:79]
  ds_read_b64_tr_b16 v[132:133], v249 offset:51200
  ds_read_b64_tr_b16 v[134:135], v249 offset:51456
  s_waitcnt vmcnt(20) lgkmcnt(8)
  v_mfma_f32_32x32x16_bf16 v[80:95], v[140:143], a[48:51], v[80:95]
  buffer_load_dwordx4 a[124:127], v2, s[48:51], s68 offen offset:3072 sc1
  ds_read_b64_tr_b16 v[136:137], v248 offset:59392
  ds_read_b64_tr_b16 v[138:139], v248 offset:59648
  v_mfma_f32_32x32x16_bf16 v[32:47], v[144:147], a[52:55], v[32:47]
  ds_read_b64_tr_b16 v[140:141], v249 offset:59392
  ds_read_b64_tr_b16 v[142:143], v249 offset:59648
  v_mfma_f32_32x32x16_bf16 v[48:63], v[148:151], a[52:55], v[48:63]
  ds_read_b64_tr_b16 v[144:145], v248 offset:52224
  ds_read_b64_tr_b16 v[146:147], v248 offset:52480
  s_waitcnt vmcnt(20) lgkmcnt(8)
  v_mfma_f32_32x32x16_bf16 v[64:79], v[152:155], a[52:55], v[64:79]
  ds_read_b64_tr_b16 v[148:149], v249 offset:52224
  ds_read_b64_tr_b16 v[150:151], v249 offset:52480
  v_mfma_f32_32x32x16_bf16 v[80:95], v[156:159], a[52:55], v[80:95]
  ds_read_b64_tr_b16 v[152:153], v248 offset:60416
  ds_read_b64_tr_b16 v[154:155], v248 offset:60672
  v_mfma_f32_32x32x16_bf16 v[32:47], v[128:131], a[56:59], v[32:47]
  ds_read_b64_tr_b16 v[156:157], v249 offset:60416
  ds_read_b64_tr_b16 v[158:159], v249 offset:60672
  s_waitcnt lgkmcnt(8)
  v_mfma_f32_32x32x16_bf16 v[48:63], v[132:135], a[56:59], v[48:63]
  ds_read_b64_tr_b16 v[128:129], v246 offset:32768
  ds_read_b64_tr_b16 v[130:131], v246 offset:33024
  v_mfma_f32_32x32x16_bf16 v[64:79], v[136:139], a[56:59], v[64:79]
  ds_read_b64_tr_b16 v[132:133], v247 offset:32768
  ds_read_b64_tr_b16 v[134:135], v247 offset:33024
  v_mfma_f32_32x32x16_bf16 v[80:95], v[140:143], a[56:59], v[80:95]
  ds_read_b64_tr_b16 v[136:137], v246 offset:40960
  ds_read_b64_tr_b16 v[138:139], v246 offset:41216
  s_waitcnt vmcnt(19) lgkmcnt(8)
  v_mfma_f32_32x32x16_bf16 v[32:47], v[144:147], a[60:63], v[32:47]
  s_add_u32 s55, s90, 6
  s_and_b32 s55, s55, 7
  s_mul_i32 s55, s55, 176128
  s_add_u32 s55, s55, s89
  s_add_u32 m0, s54, 147456
  s_nop 0
  buffer_load_dwordx4 v244, s[24:27], s55 offen offset:0 lds
  s_add_u32 m0, s54, 155584
  s_nop 0
  buffer_load_dwordx4 v244, s[24:27], s55 offen offset:64 lds
  s_add_u32 m0, s54, 65408
  s_nop 0
  buffer_load_dwordx4 v244, s[24:27], s55 offen offset:128 lds
  s_lshl2_add_u32 s69, s99, s93
  s_add_u32 m0, s54, 98304
  s_nop 0
  buffer_load_dwordx4 v12, s[32:35], s69 offen lds
  ds_read_b64_tr_b16 v[140:141], v247 offset:40960
  ds_read_b64_tr_b16 v[142:143], v247 offset:41216
  v_mfma_f32_32x32x16_bf16 v[48:63], v[148:151], a[60:63], v[48:63]
  ds_read_b64_tr_b16 v[144:145], v246 offset:33792
  ds_read_b64_tr_b16 v[146:147], v246 offset:34048
  v_mfma_f32_32x32x16_bf16 v[64:79], v[152:155], a[60:63], v[64:79]
  s_add_u32 m0, s54, 102400
  s_nop 0
  buffer_load_dwordx4 v15, s[32:35], s69 offen lds
  ds_read_b64_tr_b16 v[148:149], v247 offset:33792
  ds_read_b64_tr_b16 v[150:151], v247 offset:34048
  s_waitcnt vmcnt(23) lgkmcnt(8)
  v_mfma_f32_32x32x16_bf16 v[80:95], v[156:159], a[60:63], v[80:95]
  ds_read_b64_tr_b16 v[152:153], v246 offset:41984
  ds_read_b64_tr_b16 v[154:155], v246 offset:42240
  v_mfma_f32_32x32x16_bf16 v[32:47], v[128:131], a[64:67], v[32:47]
  s_barrier
  ds_read_b64_tr_b16 v[156:157], v247 offset:41984
  ds_read_b64_tr_b16 v[158:159], v247 offset:42240
  v_mfma_f32_32x32x16_bf16 v[48:63], v[132:135], a[64:67], v[48:63]
  s_add_u32 s55, s90, 7
  s_and_b32 s55, s55, 7
  s_mul_i32 s55, s55, 176128
  s_add_u32 s55, s55, s89
  s_add_u32 m0, s54, 73728
  s_nop 0
  buffer_load_dwordx4 v244, s[24:27], s55 offen offset:0 lds
  s_add_u32 m0, s54, 114624
  s_nop 0
  buffer_load_dwordx4 v244, s[24:27], s55 offen offset:64 lds
  s_add_u32 m0, s54, 122752
  s_nop 0
  buffer_load_dwordx4 v244, s[24:27], s55 offen offset:128 lds
  ds_read_b64_tr_b16 v[128:129], v246 offset:34816
  ds_read_b64_tr_b16 v[130:131], v246 offset:35072
  s_waitcnt vmcnt(25) lgkmcnt(8)
  v_mfma_f32_32x32x16_bf16 v[64:79], v[136:139], a[64:67], v[64:79]
  ds_read_b64_tr_b16 v[132:133], v247 offset:34816
  ds_read_b64_tr_b16 v[134:135], v247 offset:35072
  v_mfma_f32_32x32x16_bf16 v[80:95], v[140:143], a[64:67], v[80:95]
  ds_read_b64_tr_b16 v[136:137], v246 offset:43008
  ds_read_b64_tr_b16 v[138:139], v246 offset:43264
  v_mfma_f32_32x32x16_bf16 v[32:47], v[144:147], a[68:71], v[32:47]
  ds_read_b64_tr_b16 v[140:141], v247 offset:43008
  ds_read_b64_tr_b16 v[142:143], v247 offset:43264
  s_waitcnt lgkmcnt(8)
  v_mfma_f32_32x32x16_bf16 v[48:63], v[148:151], a[68:71], v[48:63]
  s_add_u32 m0, s54, 0
  s_nop 0
  buffer_load_dwordx4 v13, s[32:35], s69 offen lds
  ds_read_b64_tr_b16 v[144:145], v246 offset:35840
  ds_read_b64_tr_b16 v[146:147], v246 offset:36096
  v_mfma_f32_32x32x16_bf16 v[64:79], v[152:155], a[68:71], v[64:79]
  ds_read_b64_tr_b16 v[148:149], v247 offset:35840
  ds_read_b64_tr_b16 v[150:151], v247 offset:36096
  v_mfma_f32_32x32x16_bf16 v[80:95], v[156:159], a[68:71], v[80:95]
  s_add_u32 m0, s54, 4096
  s_nop 0
  buffer_load_dwordx4 v11, s[32:35], s69 offen lds
  ds_read_b64_tr_b16 v[152:153], v246 offset:44032
  ds_read_b64_tr_b16 v[154:155], v246 offset:44288
  s_waitcnt vmcnt(26) lgkmcnt(8)
  v_mfma_f32_32x32x16_bf16 v[32:47], v[128:131], a[72:75], v[32:47]
  ds_read_b64_tr_b16 v[156:157], v247 offset:44032
  ds_read_b64_tr_b16 v[158:159], v247 offset:44288
  v_mfma_f32_32x32x16_bf16 v[48:63], v[132:135], a[72:75], v[48:63]
  ds_read_b64_tr_b16 v[128:129], v246 offset:49152
  ds_read_b64_tr_b16 v[130:131], v246 offset:49408
  v_mfma_f32_32x32x16_bf16 v[64:79], v[136:139], a[72:75], v[64:79]
  ds_read_b64_tr_b16 v[132:133], v247 offset:49152
  ds_read_b64_tr_b16 v[134:135], v247 offset:49408
  s_waitcnt vmcnt(25) lgkmcnt(8)
  v_mfma_f32_32x32x16_bf16 v[80:95], v[140:143], a[72:75], v[80:95]
  ds_read_b64_tr_b16 v[136:137], v246 offset:57344
  ds_read_b64_tr_b16 v[138:139], v246 offset:57600
  v_mfma_f32_32x32x16_bf16 v[32:47], v[144:147], a[76:79], v[32:47]
  ds_read_b64_tr_b16 v[140:141], v247 offset:57344
  ds_read_b64_tr_b16 v[142:143], v247 offset:57600
  v_mfma_f32_32x32x16_bf16 v[48:63], v[148:151], a[76:79], v[48:63]
  ds_read_b64_tr_b16 v[144:145], v246 offset:50176
  ds_read_b64_tr_b16 v[146:147], v246 offset:50432
  s_waitcnt vmcnt(24) lgkmcnt(8)
  v_mfma_f32_32x32x16_bf16 v[64:79], v[152:155], a[76:79], v[64:79]
  s_add_u32 s55, s90, 7
  s_and_b32 s55, s55, 7
  s_mul_i32 s55, s55, 176128
  s_add_u32 s55, s55, s89
  s_add_u32 m0, s54, 77824
  s_nop 0
  buffer_load_dwordx4 v245, s[28:31], s55 offen offset:0 lds
  s_add_u32 m0, s54, 118720
  s_nop 0
  buffer_load_dwordx4 v245, s[28:31], s55 offen offset:64 lds
  s_add_u32 m0, s54, 126848
  s_nop 0
  buffer_load_dwordx4 v245, s[28:31], s55 offen offset:128 lds
  s_lshl2_add_u32 s69, s98, s93
  s_add_u32 m0, s54, 8192
  s_nop 0
  buffer_load_dwordx4 v12, s[32:35], s69 offen lds
  ds_read_b64_tr_b16 v[148:149], v247 offset:50176
  ds_read_b64_tr_b16 v[150:151], v247 offset:50432
  v_mfma_f32_32x32x16_bf16 v[80:95], v[156:159], a[76:79], v[80:95]
  ds_read_b64_tr_b16 v[152:153], v246 offset:58368
  ds_read_b64_tr_b16 v[154:155], v246 offset:58624
  v_mfma_f32_32x32x16_bf16 v[32:47], v[128:131], a[80:83], v[32:47]
  s_add_u32 m0, s54, 12288
  s_nop 0
  buffer_load_dwordx4 v15, s[32:35], s69 offen lds
  s_waitcnt vmcnt(12)
  s_barrier
  ds_read_b64_tr_b16 v[156:157], v247 offset:58368
  ds_read_b64_tr_b16 v[158:159], v247 offset:58624
  s_waitcnt lgkmcnt(8)
  v_mfma_f32_32x32x16_bf16 v[48:63], v[132:135], a[80:83], v[48:63]
  ds_read_b64_tr_b16 v[128:129], v246 offset:51200
  ds_read_b64_tr_b16 v[130:131], v246 offset:51456
  v_mfma_f32_32x32x16_bf16 v[64:79], v[136:139], a[80:83], v[64:79]
  s_waitcnt vmcnt(10)
  ds_read_b64_tr_b16 a[248:249], v226 offset:32768
  ds_read_b64_tr_b16 a[250:251], v226 offset:33024
  ds_read_b64_tr_b16 a[252:253], v227 offset:32768
  ds_read_b64_tr_b16 a[254:255], v227 offset:33024
  ds_read_b64_tr_b16 v[132:133], v247 offset:51200
  ds_read_b64_tr_b16 v[134:135], v247 offset:51456
  v_mfma_f32_32x32x16_bf16 v[80:95], v[140:143], a[80:83], v[80:95]
  ds_read_b64_tr_b16 v[136:137], v246 offset:59392
  ds_read_b64_tr_b16 v[138:139], v246 offset:59648
  s_waitcnt vmcnt(28) lgkmcnt(12)
  v_mfma_f32_32x32x16_bf16 v[32:47], v[144:147], a[84:87], v[32:47]
  ds_read_b64_tr_b16 v[140:141], v247 offset:59392
  ds_read_b64_tr_b16 v[142:143], v247 offset:59648
  v_mfma_f32_32x32x16_bf16 v[48:63], v[148:151], a[84:87], v[48:63]
  ds_read_b64_tr_b16 v[144:145], v246 offset:52224
  ds_read_b64_tr_b16 v[146:147], v246 offset:52480
  v_mfma_f32_32x32x16_bf16 v[64:79], v[152:155], a[84:87], v[64:79]
  ds_read_b64_tr_b16 v[148:149], v247 offset:52224
  ds_read_b64_tr_b16 v[150:151], v247 offset:52480
  s_waitcnt vmcnt(27) lgkmcnt(8)
  v_mfma_f32_32x32x16_bf16 v[80:95], v[156:159], a[84:87], v[80:95]
  s_add_u32 m0, s54, 98304
  s_nop 0
  buffer_load_dwordx4 v13, s[32:35], s69 offen lds
  ds_read_b64_tr_b16 v[152:153], v246 offset:60416
  ds_read_b64_tr_b16 v[154:155], v246 offset:60672
  v_mfma_f32_32x32x16_bf16 v[32:47], v[128:131], a[88:91], v[32:47]
  ds_read_b64_tr_b16 v[156:157], v247 offset:60416
  ds_read_b64_tr_b16 v[158:159], v247 offset:60672
  v_mfma_f32_32x32x16_bf16 v[48:63], v[132:135], a[88:91], v[48:63]
  s_add_u32 m0, s54, 102400
  s_nop 0
  buffer_load_dwordx4 v11, s[32:35], s69 offen lds
  ds_read_b64_tr_b16 v[128:129], v250 offset:16384
  ds_read_b64_tr_b16 v[130:131], v250 offset:16640
  s_waitcnt vmcnt(28) lgkmcnt(8)
  v_mfma_f32_32x32x16_bf16 v[64:79], v[136:139], a[88:91], v[64:79]
  ds_read_b64_tr_b16 v[132:133], v251 offset:16384
  ds_read_b64_tr_b16 v[134:135], v251 offset:16640
  v_mfma_f32_32x32x16_bf16 v[80:95], v[140:143], a[88:91], v[80:95]
  s_waitcnt vmcnt(7)
  ds_read_b64_tr_b16 a[240:241], v224 offset:0
  ds_read_b64_tr_b16 a[242:243], v224 offset:256
  ds_read_b64_tr_b16 a[244:245], v225 offset:0
  ds_read_b64_tr_b16 a[246:247], v225 offset:256
  ds_read_b64_tr_b16 v[136:137], v250 offset:24576
  ds_read_b64_tr_b16 v[138:139], v250 offset:24832
  v_mfma_f32_32x32x16_bf16 v[32:47], v[144:147], a[92:95], v[32:47]
  ds_read_b64_tr_b16 v[140:141], v251 offset:24576
  ds_read_b64_tr_b16 v[142:143], v251 offset:24832
  s_waitcnt lgkmcnt(12)
  v_mfma_f32_32x32x16_bf16 v[48:63], v[148:151], a[92:95], v[48:63]
  ds_read_b64_tr_b16 v[144:145], v250 offset:17408
  ds_read_b64_tr_b16 v[146:147], v250 offset:17664
  v_mfma_f32_32x32x16_bf16 v[64:79], v[152:155], a[92:95], v[64:79]
  ds_read_b64_tr_b16 v[148:149], v251 offset:17408
  ds_read_b64_tr_b16 v[150:151], v251 offset:17664
  v_mfma_f32_32x32x16_bf16 v[80:95], v[156:159], a[92:95], v[80:95]
  ds_read_b64_tr_b16 v[152:153], v250 offset:25600
  ds_read_b64_tr_b16 v[154:155], v250 offset:25856
  s_waitcnt vmcnt(27) lgkmcnt(8)
  v_mfma_f32_32x32x16_bf16 v[32:47], v[128:131], a[96:99], v[32:47]
  s_lshl2_add_u32 s69, s97, s93
  s_add_u32 m0, s54, 0
  s_nop 0
  buffer_load_dwordx4 v12, s[32:35], s69 offen lds
  ds_read_b64_tr_b16 v[156:157], v251 offset:25600
  ds_read_b64_tr_b16 v[158:159], v251 offset:25856
  v_mfma_f32_32x32x16_bf16 v[48:63], v[132:135], a[96:99], v[48:63]
  ds_read_b64_tr_b16 v[128:129], v250 offset:18432
  ds_read_b64_tr_b16 v[130:131], v250 offset:18688
  v_mfma_f32_32x32x16_bf16 v[64:79], v[136:139], a[96:99], v[64:79]
  s_add_u32 m0, s54, 4096
  s_nop 0
  buffer_load_dwordx4 v15, s[32:35], s69 offen lds
  ds_read_b64_tr_b16 v[132:133], v251 offset:18432
  ds_read_b64_tr_b16 v[134:135], v251 offset:18688
  s_waitcnt vmcnt(28) lgkmcnt(8)
  v_mfma_f32_32x32x16_bf16 v[80:95], v[140:143], a[96:99], v[80:95]
  ds_read_b64_tr_b16 v[136:137], v250 offset:26624
  ds_read_b64_tr_b16 v[138:139], v250 offset:26880
  v_mfma_f32_32x32x16_bf16 v[32:47], v[144:147], a[100:103], v[32:47]
  s_waitcnt vmcnt(4)
  ds_read_b64_tr_b16 a[232:233], v224 offset:8192
  ds_read_b64_tr_b16 a[234:235], v224 offset:8448
  ds_read_b64_tr_b16 a[236:237], v225 offset:8192
  ds_read_b64_tr_b16 a[238:239], v225 offset:8448
  s_lshl2_add_u32 s67, s82, s93
  s_add_u32 m0, s54, 32768
  s_nop 0
  buffer_load_dwordx4 v13, s[32:35], s67 offen lds
  ds_read_b64_tr_b16 v[140:141], v251 offset:26624
  ds_read_b64_tr_b16 v[142:143], v251 offset:26880
  v_mfma_f32_32x32x16_bf16 v[48:63], v[148:151], a[100:103], v[48:63]
  ds_read_b64_tr_b16 v[144:145], v250 offset:19456
  ds_read_b64_tr_b16 v[146:147], v250 offset:19712
  s_waitcnt vmcnt(28) lgkmcnt(12)
  v_mfma_f32_32x32x16_bf16 v[64:79], v[152:155], a[100:103], v[64:79]
  ds_read_b64_tr_b16 v[148:149], v251 offset:19456
  ds_read_b64_tr_b16 v[150:151], v251 offset:19712
  v_mfma_f32_32x32x16_bf16 v[80:95], v[156:159], a[100:103], v[80:95]
  ds_read_b64_tr_b16 v[152:153], v250 offset:27648
  ds_read_b64_tr_b16 v[154:155], v250 offset:27904
  v_mfma_f32_32x32x16_bf16 v[32:47], v[128:131], a[104:107], v[32:47]
  s_add_u32 m0, s54, 36864
  s_nop 0
  buffer_load_dwordx4 v11, s[32:35], s67 offen lds
  s_waitcnt vmcnt(8)
  s_barrier
  ds_read_b64_tr_b16 v[156:157], v251 offset:27648
  ds_read_b64_tr_b16 v[158:159], v251 offset:27904
  s_waitcnt lgkmcnt(8)
  v_mfma_f32_32x32x16_bf16 v[48:63], v[132:135], a[104:107], v[48:63]
  s_add_u32 m0, s54, 8192
  s_nop 0
  buffer_load_dwordx4 v13, s[32:35], s69 offen lds
  ds_read_b64_tr_b16 v[128:129], v248 offset:8192
  ds_read_b64_tr_b16 v[130:131], v248 offset:8448
  v_mfma_f32_32x32x16_bf16 v[64:79], v[136:139], a[104:107], v[64:79]
  ds_read_b64_tr_b16 v[132:133], v248 offset:9216
  ds_read_b64_tr_b16 v[134:135], v248 offset:9472
  v_mfma_f32_32x32x16_bf16 v[80:95], v[140:143], a[104:107], v[80:95]
  s_add_u32 m0, s54, 12288
  s_nop 0
  buffer_load_dwordx4 v11, s[32:35], s69 offen lds
  ds_read_b64_tr_b16 v[136:137], v248 offset:10240
  ds_read_b64_tr_b16 v[138:139], v248 offset:10496
  s_waitcnt vmcnt(30) lgkmcnt(8)
  v_mfma_f32_32x32x16_bf16 v[32:47], v[144:147], a[108:111], v[32:47]
  s_add_u32 m0, s54, 40960
  s_nop 0
  buffer_load_dwordx4 v12, s[32:35], s67 offen lds
  ds_read_b64_tr_b16 v[140:141], v248 offset:11264
  ds_read_b64_tr_b16 v[142:143], v248 offset:11520
  v_mfma_f32_32x32x16_bf16 v[48:63], v[148:151], a[108:111], v[48:63]
  s_waitcnt vmcnt(7)
  ds_read_b64_tr_b16 a[224:225], v226 offset:32768
  ds_read_b64_tr_b16 a[226:227], v226 offset:33024
  ds_read_b64_tr_b16 a[228:229], v227 offset:32768
  ds_read_b64_tr_b16 a[230:231], v227 offset:33024
  ds_read_b64_tr_b16 v[144:145], v249 offset:8192
  ds_read_b64_tr_b16 v[146:147], v249 offset:8448
  v_mfma_f32_32x32x16_bf16 v[64:79], v[152:155], a[108:111], v[64:79]
  ds_read_b64_tr_b16 v[148:149], v249 offset:9216
  ds_read_b64_tr_b16 v[150:151], v249 offset:9472
  s_waitcnt vmcnt(29) lgkmcnt(12)
  v_mfma_f32_32x32x16_bf16 v[80:95], v[156:159], a[108:111], v[80:95]
  ds_read_b64_tr_b16 v[152:153], v249 offset:10240
  ds_read_b64_tr_b16 v[154:155], v249 offset:10496
  v_mfma_f32_32x32x16_bf16 v[32:47], v[128:131], a[112:115], v[32:47]
  s_add_u32 m0, s54, 45056
  s_nop 0
  buffer_load_dwordx4 v15, s[32:35], s67 offen lds
  s_barrier
  ds_read_b64_tr_b16 v[156:157], v249 offset:11264
  ds_read_b64_tr_b16 v[158:159], v249 offset:11520
  v_mfma_f32_32x32x16_bf16 v[32:47], v[132:135], a[116:119], v[32:47]
  ds_read_b64_tr_b16 v[128:129], v248 offset:49152
  ds_read_b64_tr_b16 v[130:131], v248 offset:49408
  s_waitcnt vmcnt(25) lgkmcnt(8)
  v_mfma_f32_32x32x16_bf16 v[32:47], v[136:139], a[120:123], v[32:47]
  s_lshl2_add_u32 s69, s96, s93
  s_add_u32 m0, s54, 98304
  s_nop 0
  buffer_load_dwordx4 v12, s[32:35], s69 offen lds
  ds_read_b64_tr_b16 v[132:133], v248 offset:50176
  ds_read_b64_tr_b16 v[134:135], v248 offset:50432
  v_mfma_f32_32x32x16_bf16 v[32:47], v[140:143], a[124:127], v[32:47]
  ds_read_b64_tr_b16 v[136:137], v248 offset:51200
  ds_read_b64_tr_b16 v[138:139], v248 offset:51456
  v_mfma_f32_32x32x16_bf16 v[48:63], v[144:147], a[112:115], v[48:63]
  s_add_u32 m0, s54, 102400
  s_nop 0
  buffer_load_dwordx4 v15, s[32:35], s69 offen lds
  s_lshl2_add_u32 s67, s83, s93
  s_add_u32 m0, s54, 49152
  s_nop 0
  buffer_load_dwordx4 v13, s[32:35], s67 offen lds
  ds_read_b64_tr_b16 v[140:141], v248 offset:52224
  ds_read_b64_tr_b16 v[142:143], v248 offset:52480
  s_waitcnt lgkmcnt(8)
  v_mfma_f32_32x32x16_bf16 v[48:63], v[148:151], a[116:119], v[48:63]
  ds_read_b64_tr_b16 v[144:145], v249 offset:49152
  ds_read_b64_tr_b16 v[146:147], v249 offset:49408
  v_mfma_f32_32x32x16_bf16 v[48:63], v[152:155], a[120:123], v[48:63]
  v_mul_f32 v32, 0xbfb8aa3b, v32
  v_mul_f32 v33, 0xbfb8aa3b, v33
  v_mul_f32 v34, 0xbfb8aa3b, v34
  v_mul_f32 v35, 0xbfb8aa3b, v35
  v_mul_f32 v36, 0xbfb8aa3b, v36
  v_mul_f32 v37, 0xbfb8aa3b, v37
  v_mul_f32 v38, 0xbfb8aa3b, v38
  v_mul_f32 v39, 0xbfb8aa3b, v39
  v_exp_f32 v32, v32
  v_exp_f32 v33, v33
  v_exp_f32 v34, v34
  v_exp_f32 v35, v35
  v_exp_f32 v36, v36
  v_exp_f32 v37, v37
  v_exp_f32 v38, v38
  v_exp_f32 v39, v39
  v_pk_add_f32 v[32:33], v[32:33], 1.0 op_sel_hi:[1,0]
  v_pk_add_f32 v[34:35], v[34:35], 1.0 op_sel_hi:[1,0]
  v_pk_add_f32 v[36:37], v[36:37], 1.0 op_sel_hi:[1,0]
  v_pk_add_f32 v[38:39], v[38:39], 1.0 op_sel_hi:[1,0]
  v_rcp_f32 v32, v32
  v_rcp_f32 v33, v33
  v_rcp_f32 v34, v34
  v_rcp_f32 v35, v35
  v_rcp_f32 v36, v36
  v_rcp_f32 v37, v37
  v_rcp_f32 v38, v38
  v_rcp_f32 v39, v39
  v_pk_mul_f32 v[32:33], v[32:33], v[40:41]
  v_pk_mul_f32 v[34:35], v[34:35], v[42:43]
  v_pk_mul_f32 v[36:37], v[36:37], v[44:45]
  v_pk_mul_f32 v[38:39], v[38:39], v[46:47]
  v_cvt_pk_bf16_f32 v32, v32, v33
  v_cvt_pk_bf16_f32 v33, v34, v35
  v_cvt_pk_bf16_f32 v34, v36, v37
  v_cvt_pk_bf16_f32 v35, v38, v39
  buffer_store_dwordx4 v[32:35], v2, s[48:51], s72 offen offset:0 sc1
  s_waitcnt vmcnt(10)
  ds_read_b64_tr_b16 a[216:217], v224 offset:0
  ds_read_b64_tr_b16 a[218:219], v224 offset:256
  ds_read_b64_tr_b16 a[220:221], v225 offset:0
  ds_read_b64_tr_b16 a[222:223], v225 offset:256
  ds_read_b64_tr_b16 v[148:149], v249 offset:50176
  ds_read_b64_tr_b16 v[150:151], v249 offset:50432
  v_mfma_f32_32x32x16_bf16 v[48:63], v[156:159], a[124:127], v[48:63]
  ds_read_b64_tr_b16 v[152:153], v249 offset:51200
  ds_read_b64_tr_b16 v[154:155], v249 offset:51456
  s_waitcnt lgkmcnt(12)
  v_mfma_f32_32x32x16_bf16 v[64:79], v[128:131], a[112:115], v[64:79]
  s_add_u32 m0, s54, 53248
  s_nop 0
  buffer_load_dwordx4 v11, s[32:35], s67 offen lds
  ds_read_b64_tr_b16 v[156:157], v249 offset:52224
  ds_read_b64_tr_b16 v[158:159], v249 offset:52480
  v_mfma_f32_32x32x16_bf16 v[64:79], v[132:135], a[116:119], v[64:79]
  ds_read_b64_tr_b16 v[128:129], v246 offset:16384
  ds_read_b64_tr_b16 v[130:131], v246 offset:16640
  v_mfma_f32_32x32x16_bf16 v[64:79], v[136:139], a[120:123], v[64:79]
  v_mul_f32 v48, 0xbfb8aa3b, v48
  v_mul_f32 v49, 0xbfb8aa3b, v49
  v_mul_f32 v50, 0xbfb8aa3b, v50
  v_mul_f32 v51, 0xbfb8aa3b, v51
  v_mul_f32 v52, 0xbfb8aa3b, v52
  v_mul_f32 v53, 0xbfb8aa3b, v53
  v_mul_f32 v54, 0xbfb8aa3b, v54
  v_mul_f32 v55, 0xbfb8aa3b, v55
  v_exp_f32 v48, v48
  v_exp_f32 v49, v49
  v_exp_f32 v50, v50
  v_exp_f32 v51, v51
  v_exp_f32 v52, v52
  v_exp_f32 v53, v53
  v_exp_f32 v54, v54
  v_exp_f32 v55, v55
  v_pk_add_f32 v[48:49], v[48:49], 1.0 op_sel_hi:[1,0]
  v_pk_add_f32 v[50:51], v[50:51], 1.0 op_sel_hi:[1,0]
  v_pk_add_f32 v[52:53], v[52:53], 1.0 op_sel_hi:[1,0]
  v_pk_add_f32 v[54:55], v[54:55], 1.0 op_sel_hi:[1,0]
  v_rcp_f32 v48, v48
  v_rcp_f32 v49, v49
  v_rcp_f32 v50, v50
  v_rcp_f32 v51, v51
  v_rcp_f32 v52, v52
  v_rcp_f32 v53, v53
  v_rcp_f32 v54, v54
  v_rcp_f32 v55, v55
  v_pk_mul_f32 v[48:49], v[48:49], v[56:57]
  v_pk_mul_f32 v[50:51], v[50:51], v[58:59]
  v_pk_mul_f32 v[52:53], v[52:53], v[60:61]
  v_pk_mul_f32 v[54:55], v[54:55], v[62:63]
  v_cvt_pk_bf16_f32 v48, v48, v49
  v_cvt_pk_bf16_f32 v49, v50, v51
  v_cvt_pk_bf16_f32 v50, v52, v53
  v_cvt_pk_bf16_f32 v51, v54, v55
  buffer_store_dwordx4 v[48:51], v2, s[48:51], s72 offen offset:1024 sc1
  s_add_u32 s72, s72, 8192
  ds_read_b64_tr_b16 v[132:133], v246 offset:17408
  ds_read_b64_tr_b16 v[134:135], v246 offset:17664
  s_waitcnt lgkmcnt(8)
  v_mfma_f32_32x32x16_bf16 v[64:79], v[140:143], a[124:127], v[64:79]
  s_add_u32 m0, s54, 0
  s_nop 0
  buffer_load_dwordx4 v13, s[32:35], s69 offen lds
  ds_read_b64_tr_b16 v[136:137], v246 offset:18432
  ds_read_b64_tr_b16 v[138:139], v246 offset:18688
  v_mfma_f32_32x32x16_bf16 v[80:95], v[144:147], a[112:115], v[80:95]
  s_add_u32 m0, s54, 57344
  s_nop 0
  buffer_load_dwordx4 v12, s[32:35], s67 offen lds
  ds_read_b64_tr_b16 v[140:141], v246 offset:19456
  ds_read_b64_tr_b16 v[142:143], v246 offset:19712
  v_mfma_f32_32x32x16_bf16 v[80:95], v[148:151], a[116:119], v[80:95]
  s_add_u32 m0, s54, 4096
  s_nop 0
  buffer_load_dwordx4 v11, s[32:35], s69 offen lds
  ds_read_b64_tr_b16 v[144:145], v250 offset:8192
  ds_read_b64_tr_b16 v[146:147], v250 offset:8448
  s_waitcnt lgkmcnt(8)
  v_mfma_f32_32x32x16_bf16 v[80:95], v[152:155], a[120:123], v[80:95]
  v_mul_f32 v64, 0xbfb8aa3b, v64
  v_mul_f32 v65, 0xbfb8aa3b, v65
  v_mul_f32 v66, 0xbfb8aa3b, v66
  v_mul_f32 v67, 0xbfb8aa3b, v67
  v_mul_f32 v68, 0xbfb8aa3b, v68
  v_mul_f32 v69, 0xbfb8aa3b, v69
  v_mul_f32 v70, 0xbfb8aa3b, v70
  v_mul_f32 v71, 0xbfb8aa3b, v71
  v_exp_f32 v64, v64
  v_exp_f32 v65, v65
  v_exp_f32 v66, v66
  v_exp_f32 v67, v67
  v_exp_f32 v68, v68
  v_exp_f32 v69, v69
  v_exp_f32 v70, v70
  v_exp_f32 v71, v71
  v_pk_add_f32 v[64:65], v[64:65], 1.0 op_sel_hi:[1,0]
  v_pk_add_f32 v[66:67], v[66:67], 1.0 op_sel_hi:[1,0]
  v_pk_add_f32 v[68:69], v[68:69], 1.0 op_sel_hi:[1,0]
  v_pk_add_f32 v[70:71], v[70:71], 1.0 op_sel_hi:[1,0]
  v_rcp_f32 v64, v64
  v_rcp_f32 v65, v65
  v_rcp_f32 v66, v66
  v_rcp_f32 v67, v67
  v_rcp_f32 v68, v68
  v_rcp_f32 v69, v69
  v_rcp_f32 v70, v70
  v_rcp_f32 v71, v71
  v_pk_mul_f32 v[64:65], v[64:65], v[72:73]
  v_pk_mul_f32 v[66:67], v[66:67], v[74:75]
  v_pk_mul_f32 v[68:69], v[68:69], v[76:77]
  v_pk_mul_f32 v[70:71], v[70:71], v[78:79]
  v_cvt_pk_bf16_f32 v64, v64, v65
  v_cvt_pk_bf16_f32 v65, v66, v67
  v_cvt_pk_bf16_f32 v66, v68, v69
  v_cvt_pk_bf16_f32 v67, v70, v71
  buffer_store_dwordx4 v[64:67], v2, s[48:51], s72 offen offset:0 sc1
  ds_read_b64_tr_b16 v[148:149], v250 offset:9216
  ds_read_b64_tr_b16 v[150:151], v250 offset:9472
  v_mfma_f32_32x32x16_bf16 v[80:95], v[156:159], a[124:127], v[80:95]
  s_waitcnt vmcnt(12)
  ds_read_b64_tr_b16 a[208:209], v224 offset:8192
  ds_read_b64_tr_b16 a[210:211], v224 offset:8448
  ds_read_b64_tr_b16 a[212:213], v225 offset:8192
  ds_read_b64_tr_b16 a[214:215], v225 offset:8448
  ds_read_b64_tr_b16 v[152:153], v250 offset:10240
  ds_read_b64_tr_b16 v[154:155], v250 offset:10496
  v_mfma_f32_32x32x16_bf16 v[96:111], v[128:131], a[0:3], 0
  s_add_u32 m0, s54, 61440
  s_nop 0
  buffer_load_dwordx4 v15, s[32:35], s67 offen lds
  s_barrier
  ds_read_b64_tr_b16 v[156:157], v250 offset:11264
  ds_read_b64_tr_b16 v[158:159], v250 offset:11520
  s_waitcnt lgkmcnt(12)
  v_mfma_f32_32x32x16_bf16 v[96:111], v[132:135], a[4:7], v[96:111]
  ds_read_b64_tr_b16 v[128:129], v248 offset:16384
  ds_read_b64_tr_b16 v[130:131], v248 offset:16640
  v_mfma_f32_32x32x16_bf16 v[96:111], v[136:139], a[8:11], v[96:111]
  v_mul_f32 v80, 0xbfb8aa3b, v80
  v_mul_f32 v81, 0xbfb8aa3b, v81
  v_mul_f32 v82, 0xbfb8aa3b, v82
  v_mul_f32 v83, 0xbfb8aa3b, v83
  v_mul_f32 v84, 0xbfb8aa3b, v84
  v_mul_f32 v85, 0xbfb8aa3b, v85
  v_mul_f32 v86, 0xbfb8aa3b, v86
  v_mul_f32 v87, 0xbfb8aa3b, v87
  v_exp_f32 v80, v80
  v_exp_f32 v81, v81
  v_exp_f32 v82, v82
  v_exp_f32 v83, v83
  v_exp_f32 v84, v84
  v_exp_f32 v85, v85
  v_exp_f32 v86, v86
  v_exp_f32 v87, v87
  v_pk_add_f32 v[80:81], v[80:81], 1.0 op_sel_hi:[1,0]
  v_pk_add_f32 v[82:83], v[82:83], 1.0 op_sel_hi:[1,0]
  v_pk_add_f32 v[84:85], v[84:85], 1.0 op_sel_hi:[1,0]
  v_pk_add_f32 v[86:87], v[86:87], 1.0 op_sel_hi:[1,0]
  v_rcp_f32 v80, v80
  v_rcp_f32 v81, v81
  v_rcp_f32 v82, v82
  v_rcp_f32 v83, v83
  v_rcp_f32 v84, v84
  v_rcp_f32 v85, v85
  v_rcp_f32 v86, v86
  v_rcp_f32 v87, v87
  v_pk_mul_f32 v[80:81], v[80:81], v[88:89]
  v_pk_mul_f32 v[82:83], v[82:83], v[90:91]
  v_pk_mul_f32 v[84:85], v[84:85], v[92:93]
  v_pk_mul_f32 v[86:87], v[86:87], v[94:95]
  v_cvt_pk_bf16_f32 v80, v80, v81
  v_cvt_pk_bf16_f32 v81, v82, v83
  v_cvt_pk_bf16_f32 v82, v84, v85
  v_cvt_pk_bf16_f32 v83, v86, v87
  buffer_store_dwordx4 v[80:83], v2, s[48:51], s72 offen offset:1024 sc1
  s_add_u32 s72, s72, 8192
  ds_read_b64_tr_b16 v[132:133], v248 offset:17408
  ds_read_b64_tr_b16 v[134:135], v248 offset:17664
  v_mfma_f32_32x32x16_bf16 v[96:111], v[140:143], a[12:15], v[96:111]
  ds_read_b64_tr_b16 v[136:137], v248 offset:18432
  ds_read_b64_tr_b16 v[138:139], v248 offset:18688
  s_waitcnt lgkmcnt(8)
  v_mfma_f32_32x32x16_bf16 v[96:111], v[144:147], a[16:19], v[96:111]
  s_lshl2_add_u32 s69, s88, s93
  s_add_u32 m0, s54, 8192
  s_nop 0
  buffer_load_dwordx4 v12, s[32:35], s69 offen lds
  s_lshl2_add_u32 s67, s84, s93
  s_add_u32 m0, s54, 147456
  s_nop 0
  buffer_load_dwordx4 v13, s[32:35], s67 offen lds
  ds_read_b64_tr_b16 v[140:141], v248 offset:19456
  ds_read_b64_tr_b16 v[142:143], v248 offset:19712
  v_mfma_f32_32x32x16_bf16 v[96:111], v[148:151], a[20:23], v[96:111]
  ds_read_b64_tr_b16 v[144:145], v250 offset:0
  ds_read_b64_tr_b16 v[146:147], v250 offset:256
  v_mfma_f32_32x32x16_bf16 v[96:111], v[152:155], a[24:27], v[96:111]
  s_add_u32 m0, s54, 12288
  s_nop 0
  buffer_load_dwordx4 v15, s[32:35], s69 offen lds
  ds_read_b64_tr_b16 v[148:149], v250 offset:1024
  ds_read_b64_tr_b16 v[150:151], v250 offset:1280
  s_waitcnt lgkmcnt(8)
  v_mfma_f32_32x32x16_bf16 v[96:111], v[156:159], a[28:31], v[96:111]
  ds_read_b64_tr_b16 v[152:153], v250 offset:2048
  ds_read_b64_tr_b16 v[154:155], v250 offset:2304
  v_mfma_f32_32x32x16_bf16 v[96:111], v[128:131], a[32:35], v[96:111]
  s_waitcnt vmcnt(13)
  ds_read_b64_tr_b16 a[200:201], v226 offset:32768
  ds_read_b64_tr_b16 a[202:203], v226 offset:33024
  ds_read_b64_tr_b16 a[204:205], v227 offset:32768
  ds_read_b64_tr_b16 a[206:207], v227 offset:33024
  s_add_u32 m0, s54, 151552
  s_nop 0
  buffer_load_dwordx4 v11, s[32:35], s67 offen lds
  ds_read_b64_tr_b16 v[156:157], v250 offset:3072
  ds_read_b64_tr_b16 v[158:159], v250 offset:3328
  v_mfma_f32_32x32x16_bf16 v[96:111], v[132:135], a[36:39], v[96:111]
  ds_read_b64_tr_b16 v[128:129], v246 offset:24576
  ds_read_b64_tr_b16 v[130:131], v246 offset:24832
  s_waitcnt lgkmcnt(12)
  v_mfma_f32_32x32x16_bf16 v[96:111], v[136:139], a[40:43], v[96:111]
  ds_read_b64_tr_b16 v[132:133], v246 offset:25600
  ds_read_b64_tr_b16 v[134:135], v246 offset:25856
  v_mfma_f32_32x32x16_bf16 v[96:111], v[140:143], a[44:47], v[96:111]
  ds_read_b64_tr_b16 v[136:137], v246 offset:26624
  ds_read_b64_tr_b16 v[138:139], v246 offset:26880
  v_mfma_f32_32x32x16_bf16 v[96:111], v[144:147], a[48:51], v[96:111]
  s_add_u32 m0, s54, 155648
  s_nop 0
  buffer_load_dwordx4 v12, s[32:35], s67 offen lds
  ds_read_b64_tr_b16 v[140:141], v246 offset:27648
  ds_read_b64_tr_b16 v[142:143], v246 offset:27904
  s_waitcnt lgkmcnt(8)
  v_mfma_f32_32x32x16_bf16 v[96:111], v[148:151], a[52:55], v[96:111]
  s_add_u32 m0, s54, 98304
  s_nop 0
  buffer_load_dwordx4 v13, s[32:35], s69 offen lds
  ds_read_b64_tr_b16 v[144:145], v248 offset:24576
  ds_read_b64_tr_b16 v[146:147], v248 offset:24832
  v_mfma_f32_32x32x16_bf16 v[96:111], v[152:155], a[56:59], v[96:111]
  ds_read_b64_tr_b16 v[148:149], v248 offset:25600
  ds_read_b64_tr_b16 v[150:151], v248 offset:25856
  v_mfma_f32_32x32x16_bf16 v[96:111], v[156:159], a[60:63], v[96:111]
  s_add_u32 m0, s54, 102400
  s_nop 0
  buffer_load_dwordx4 v11, s[32:35], s69 offen lds
  ds_read_b64_tr_b16 v[152:153], v248 offset:26624
  ds_read_b64_tr_b16 v[154:155], v248 offset:26880
  s_waitcnt lgkmcnt(8)
  v_mfma_f32_32x32x16_bf16 v[96:111], v[128:131], a[64:67], v[96:111]
  s_add_u32 m0, s54, 159744
  s_nop 0
  buffer_load_dwordx4 v15, s[32:35], s67 offen lds
  ds_read_b64_tr_b16 v[156:157], v248 offset:27648
  ds_read_b64_tr_b16 v[158:159], v248 offset:27904
  v_mfma_f32_32x32x16_bf16 v[96:111], v[132:135], a[68:71], v[96:111]
  s_waitcnt vmcnt(11)
  ds_read_b64_tr_b16 a[192:193], v224 offset:0
  ds_read_b64_tr_b16 a[194:195], v224 offset:256
  ds_read_b64_tr_b16 a[196:197], v225 offset:0
  ds_read_b64_tr_b16 a[198:199], v225 offset:256
  ds_read_b64_tr_b16 v[128:129], v248 offset:0
  ds_read_b64_tr_b16 v[130:131], v248 offset:256
  v_mfma_f32_32x32x16_bf16 v[96:111], v[136:139], a[72:75], v[96:111]
  ds_read_b64_tr_b16 v[132:133], v248 offset:1024
  ds_read_b64_tr_b16 v[134:135], v248 offset:1280
  s_waitcnt lgkmcnt(12)
  v_mfma_f32_32x32x16_bf16 v[96:111], v[140:143], a[76:79], v[96:111]
  ds_read_b64_tr_b16 v[136:137], v248 offset:2048
  ds_read_b64_tr_b16 v[138:139], v248 offset:2304
  v_mfma_f32_32x32x16_bf16 v[96:111], v[144:147], a[80:83], v[96:111]
  s_lshl2_add_u32 s67, s85, s93
  s_add_u32 m0, s54, 73728
  s_nop 0
  buffer_load_dwordx4 v13, s[32:35], s67 offen lds
  ds_read_b64_tr_b16 v[140:141], v248 offset:3072
  ds_read_b64_tr_b16 v[142:143], v248 offset:3328
  v_mfma_f32_32x32x16_bf16 v[96:111], v[148:151], a[84:87], v[96:111]
  ds_read_b64_tr_b16 v[144:145], v248 offset:57344
  ds_read_b64_tr_b16 v[146:147], v248 offset:57600
  s_waitcnt lgkmcnt(8)
  v_mfma_f32_32x32x16_bf16 v[96:111], v[152:155], a[88:91], v[96:111]
  s_lshl2_add_u32 s69, s87, s93
  s_add_u32 m0, s54, 0
  s_nop 0
  buffer_load_dwordx4 v12, s[32:35], s69 offen lds
  ds_read_b64_tr_b16 v[148:149], v248 offset:58368
  ds_read_b64_tr_b16 v[150:151], v248 offset:58624
  v_mfma_f32_32x32x16_bf16 v[96:111], v[156:159], a[92:95], v[96:111]
  ds_read_b64_tr_b16 v[152:153], v248 offset:59392
  ds_read_b64_tr_b16 v[154:155], v248 offset:59648
  v_mfma_f32_32x32x16_bf16 v[96:111], v[128:131], a[96:99], v[96:111]
  s_add_u32 m0, s54, 4096
  s_nop 0
  buffer_load_dwordx4 v15, s[32:35], s69 offen lds
  s_add_u32 m0, s54, 77824
  s_nop 0
  buffer_load_dwordx4 v11, s[32:35], s67 offen lds
  ds_read_b64_tr_b16 v[156:157], v248 offset:60416
  ds_read_b64_tr_b16 v[158:159], v248 offset:60672
  s_waitcnt lgkmcnt(8)
  v_mfma_f32_32x32x16_bf16 v[96:111], v[132:135], a[100:103], v[96:111]
  ds_read_b64_tr_b16 v[128:129], v247 offset:16384
  ds_read_b64_tr_b16 v[130:131], v247 offset:16640
  v_mfma_f32_32x32x16_bf16 v[96:111], v[136:139], a[104:107], v[96:111]
  s_waitcnt vmcnt(9)
  ds_read_b64_tr_b16 a[184:185], v224 offset:8192
  ds_read_b64_tr_b16 a[186:187], v224 offset:8448
  ds_read_b64_tr_b16 a[188:189], v225 offset:8192
  ds_read_b64_tr_b16 a[190:191], v225 offset:8448
  ds_read_b64_tr_b16 v[132:133], v247 offset:17408
  ds_read_b64_tr_b16 v[134:135], v247 offset:17664
  v_mfma_f32_32x32x16_bf16 v[96:111], v[140:143], a[108:111], v[96:111]
  ds_read_b64_tr_b16 v[136:137], v247 offset:18432
  ds_read_b64_tr_b16 v[138:139], v247 offset:18688
  s_waitcnt lgkmcnt(12)
  v_mfma_f32_32x32x16_bf16 v[96:111], v[144:147], a[112:115], v[96:111]
  s_add_u32 m0, s54, 114688
  s_nop 0
  buffer_load_dwordx4 v12, s[32:35], s67 offen lds
  v_mov_b32 v3, 0
  v_mov_b32 v4, s56
  s_waitcnt vmcnt(13)
  s_mov_b64 exec, 1
  s_cmp_eq_u32 s57, 0
  s_cbranch_scc1 L_60
  buffer_store_dword v4, v3, s[48:51], s73 offen offset:1024
  s_branch L_61
L_60:
  buffer_store_dword v4, v3, s[48:51], s73 offen offset:1024 sc1
L_61:
  s_mov_b64 exec, -1
  ds_read_b64_tr_b16 v[140:141], v247 offset:19456
  ds_read_b64_tr_b16 v[142:143], v247 offset:19712
  v_mfma_f32_32x32x16_bf16 v[96:111], v[148:151], a[116:119], v[96:111]
  ds_read_b64_tr_b16 v[144:145], v251 offset:8192
  ds_read_b64_tr_b16 v[146:147], v251 offset:8448
  v_mfma_f32_32x32x16_bf16 v[96:111], v[152:155], a[120:123], v[96:111]
  ds_read_b64_tr_b16 v[148:149], v251 offset:9216
  ds_read_b64_tr_b16 v[150:151], v251 offset:9472
  s_waitcnt lgkmcnt(8)
  v_mfma_f32_32x32x16_bf16 v[96:111], v[156:159], a[124:127], v[96:111]
  s_add_u32 m0, s54, 8192
  s_nop 0
  buffer_load_dwordx4 v13, s[32:35], s69 offen lds
  ds_read_b64_tr_b16 v[152:153], v251 offset:10240
  ds_read_b64_tr_b16 v[154:155], v251 offset:10496
  v_mfma_f32_32x32x16_bf16 v[112:127], v[128:131], a[0:3], 0
  s_add_u32 m0, s54, 118784
  s_nop 0
  buffer_load_dwordx4 v15, s[32:35], s67 offen lds
  ds_read_b64_tr_b16 v[156:157], v251 offset:11264
  ds_read_b64_tr_b16 v[158:159], v251 offset:11520
  v_mfma_f32_32x32x16_bf16 v[112:127], v[132:135], a[4:7], v[112:127]
  s_add_u32 m0, s54, 12288
  s_nop 0
  buffer_load_dwordx4 v11, s[32:35], s69 offen lds
  ds_read_b64_tr_b16 v[128:129], v249 offset:16384
  ds_read_b64_tr_b16 v[130:131], v249 offset:16640
  s_waitcnt lgkmcnt(8)
  v_mfma_f32_32x32x16_bf16 v[112:127], v[136:139], a[8:11], v[112:127]
  v_mul_f32 v96, 0xbfb8aa3b, v96
  v_mul_f32 v97, 0xbfb8aa3b, v97
  v_mul_f32 v98, 0xbfb8aa3b, v98
  v_mul_f32 v99, 0xbfb8aa3b, v99
  v_mul_f32 v100, 0xbfb8aa3b, v100
  v_mul_f32 v101, 0xbfb8aa3b, v101
  v_mul_f32 v102, 0xbfb8aa3b, v102
  v_mul_f32 v103, 0xbfb8aa3b, v103
  v_exp_f32 v96, v96
  v_exp_f32 v97, v97
  v_exp_f32 v98, v98
  v_exp_f32 v99, v99
  v_exp_f32 v100, v100
  v_exp_f32 v101, v101
  v_exp_f32 v102, v102
  v_exp_f32 v103, v103
  v_pk_add_f32 v[96:97], v[96:97], 1.0 op_sel_hi:[1,0]
  v_pk_add_f32 v[98:99], v[98:99], 1.0 op_sel_hi:[1,0]
  v_pk_add_f32 v[100:101], v[100:101], 1.0 op_sel_hi:[1,0]
  v_pk_add_f32 v[102:103], v[102:103], 1.0 op_sel_hi:[1,0]
  v_rcp_f32 v96, v96
  v_rcp_f32 v97, v97
  v_rcp_f32 v98, v98
  v_rcp_f32 v99, v99
  v_rcp_f32 v100, v100
  v_rcp_f32 v101, v101
  v_rcp_f32 v102, v102
  v_rcp_f32 v103, v103
  v_pk_mul_f32 v[96:97], v[96:97], v[104:105]
  v_pk_mul_f32 v[98:99], v[98:99], v[106:107]
  v_pk_mul_f32 v[100:101], v[100:101], v[108:109]
  v_pk_mul_f32 v[102:103], v[102:103], v[110:111]
  v_cvt_pk_bf16_f32 v96, v96, v97
  v_cvt_pk_bf16_f32 v97, v98, v99
  v_cvt_pk_bf16_f32 v98, v100, v101
  v_cvt_pk_bf16_f32 v99, v102, v103
  buffer_store_dwordx4 v[96:99], v2, s[48:51], s72 offen offset:0 sc1
  ds_read_b64_tr_b16 v[132:133], v249 offset:17408
  ds_read_b64_tr_b16 v[134:135], v249 offset:17664
  v_mfma_f32_32x32x16_bf16 v[112:127], v[140:143], a[12:15], v[112:127]
  s_waitcnt vmcnt(11)
  ds_read_b64_tr_b16 a[176:177], v226 offset:32768
  ds_read_b64_tr_b16 a[178:179], v226 offset:33024
  ds_read_b64_tr_b16 a[180:181], v227 offset:32768
  ds_read_b64_tr_b16 a[182:183], v227 offset:33024
  ds_read_b64_tr_b16 v[136:137], v249 offset:18432
  ds_read_b64_tr_b16 v[138:139], v249 offset:18688
  v_mfma_f32_32x32x16_bf16 v[112:127], v[144:147], a[16:19], v[112:127]
  ds_read_b64_tr_b16 v[140:141], v249 offset:19456
  ds_read_b64_tr_b16 v[142:143], v249 offset:19712
  s_waitcnt lgkmcnt(12)
  v_mfma_f32_32x32x16_bf16 v[112:127], v[148:151], a[20:23], v[112:127]
  ds_read_b64_tr_b16 v[144:145], v251 offset:0
  ds_read_b64_tr_b16 v[146:147], v251 offset:256
  v_mfma_f32_32x32x16_bf16 v[112:127], v[152:155], a[24:27], v[112:127]
  ds_read_b64_tr_b16 v[148:149], v251 offset:1024
  ds_read_b64_tr_b16 v[150:151], v251 offset:1280
  v_mfma_f32_32x32x16_bf16 v[112:127], v[156:159], a[28:31], v[112:127]
  ds_read_b64_tr_b16 v[152:153], v251 offset:2048
  ds_read_b64_tr_b16 v[154:155], v251 offset:2304
  s_waitcnt lgkmcnt(8)
  v_mfma_f32_32x32x16_bf16 v[112:127], v[128:131], a[32:35], v[112:127]
  s_lshl2_add_u32 s69, s86, s93
  s_add_u32 m0, s54, 98304
  s_nop 0
  buffer_load_dwordx4 v12, s[32:35], s69 offen lds
  ds_read_b64_tr_b16 v[156:157], v251 offset:3072
  ds_read_b64_tr_b16 v[158:159], v251 offset:3328
  v_mfma_f32_32x32x16_bf16 v[112:127], v[132:135], a[36:39], v[112:127]
  ds_read_b64_tr_b16 v[128:129], v247 offset:24576
  ds_read_b64_tr_b16 v[130:131], v247 offset:24832
  v_mfma_f32_32x32x16_bf16 v[112:127], v[136:139], a[40:43], v[112:127]
  s_add_u32 m0, s54, 102400
  s_nop 0
  buffer_load_dwordx4 v15, s[32:35], s69 offen lds
  ds_read_b64_tr_b16 v[132:133], v247 offset:25600
  ds_read_b64_tr_b16 v[134:135], v247 offset:25856
  s_waitcnt lgkmcnt(8)
  v_mfma_f32_32x32x16_bf16 v[112:127], v[140:143], a[44:47], v[112:127]
  ds_read_b64_tr_b16 v[136:137], v247 offset:26624
  ds_read_b64_tr_b16 v[138:139], v247 offset:26880
  v_mfma_f32_32x32x16_bf16 v[112:127], v[144:147], a[48:51], v[112:127]
  s_waitcnt vmcnt(9)
  ds_read_b64_tr_b16 a[168:169], v224 offset:0
  ds_read_b64_tr_b16 a[170:171], v224 offset:256
  ds_read_b64_tr_b16 a[172:173], v225 offset:0
  ds_read_b64_tr_b16 a[174:175], v225 offset:256
  ds_read_b64_tr_b16 v[140:141], v247 offset:27648
  ds_read_b64_tr_b16 v[142:143], v247 offset:27904
  v_mfma_f32_32x32x16_bf16 v[112:127], v[148:151], a[52:55], v[112:127]
  ds_read_b64_tr_b16 v[144:145], v249 offset:24576
  ds_read_b64_tr_b16 v[146:147], v249 offset:24832
  s_waitcnt lgkmcnt(12)
  v_mfma_f32_32x32x16_bf16 v[112:127], v[152:155], a[56:59], v[112:127]
  ds_read_b64_tr_b16 v[148:149], v249 offset:25600
  ds_read_b64_tr_b16 v[150:151], v249 offset:25856
  v_mfma_f32_32x32x16_bf16 v[112:127], v[156:159], a[60:63], v[112:127]
  ds_read_b64_tr_b16 v[152:153], v249 offset:26624
  ds_read_b64_tr_b16 v[154:155], v249 offset:26880
  v_mfma_f32_32x32x16_bf16 v[112:127], v[128:131], a[64:67], v[112:127]
  ds_read_b64_tr_b16 v[156:157], v249 offset:27648
  ds_read_b64_tr_b16 v[158:159], v249 offset:27904
  s_waitcnt lgkmcnt(8)
  v_mfma_f32_32x32x16_bf16 v[112:127], v[132:135], a[68:71], v[112:127]
  s_add_u32 m0, s54, 0
  s_nop 0
  buffer_load_dwordx4 v13, s[32:35], s69 offen lds
  ds_read_b64_tr_b16 v[128:129], v249 offset:0
  ds_read_b64_tr_b16 v[130:131], v249 offset:256
  v_mfma_f32_32x32x16_bf16 v[112:127], v[136:139], a[72:75], v[112:127]
  buffer_load_dword v231, v230, s[48:51], s70 offen offset:1024 sc1
  ds_read_b64_tr_b16 v[132:133], v249 offset:1024
  ds_read_b64_tr_b16 v[134:135], v249 offset:1280
  v_mfma_f32_32x32x16_bf16 v[112:127], v[140:143], a[76:79], v[112:127]
  s_add_u32 m0, s54, 4096
  s_nop 0
  buffer_load_dwordx4 v11, s[32:35], s69 offen lds
  ds_read_b64_tr_b16 v[136:137], v249 offset:2048
  ds_read_b64_tr_b16 v[138:139], v249 offset:2304
  s_waitcnt lgkmcnt(8)
  v_mfma_f32_32x32x16_bf16 v[112:127], v[144:147], a[80:83], v[112:127]
  ds_read_b64_tr_b16 v[140:141], v249 offset:3072
  ds_read_b64_tr_b16 v[142:143], v249 offset:3328
  v_mfma_f32_32x32x16_bf16 v[112:127], v[148:151], a[84:87], v[112:127]
  ds_read_b64_tr_b16 v[144:145], v249 offset:57344
  ds_read_b64_tr_b16 v[146:147], v249 offset:57600
  v_mfma_f32_32x32x16_bf16 v[112:127], v[152:155], a[88:91], v[112:127]
  ds_read_b64_tr_b16 v[148:149], v249 offset:58368
  ds_read_b64_tr_b16 v[150:151], v249 offset:58624
  s_waitcnt lgkmcnt(8)
  v_mfma_f32_32x32x16_bf16 v[112:127], v[156:159], a[92:95], v[112:127]
  ds_read_b64_tr_b16 v[152:153], v249 offset:59392
  ds_read_b64_tr_b16 v[154:155], v249 offset:59648
  v_mfma_f32_32x32x16_bf16 v[112:127], v[128:131], a[96:99], v[112:127]
  s_mov_b32 s65, 0
  s_waitcnt vmcnt(1)
  v_cmp_ne_u32 vcc, s56, v231
  s_cbranch_vccz PD_62
  s_mov_b32 s65, 0
P_63:
  buffer_load_dword v231, v230, s[48:51], s70 offen offset:1024 sc1
  s_add_u32 s65, s65, 1
  s_cmp_gt_u32 s65, 20000
  s_cbranch_scc1 PE_64
  s_waitcnt vmcnt(0)
  v_cmp_ne_u32 vcc, s56, v231
  s_cbranch_vccnz P_63
PE_64:
  s_waitcnt vmcnt(0)
PD_62:
  buffer_load_dwordx4 v[160:163], v8, s[48:51], s82 offen offset:0 sc1
  ds_read_b64_tr_b16 v[156:157], v249 offset:60416
  ds_read_b64_tr_b16 v[158:159], v249 offset:60672
  v_mfma_f32_32x32x16_bf16 v[112:127], v[132:135], a[100:103], v[112:127]
  s_waitcnt lgkmcnt(6)
  v_mfma_f32_32x32x16_bf16 v[112:127], v[136:139], a[104:107], v[112:127]
  buffer_load_dwordx4 v[164:167], v9, s[48:51], s82 offen offset:0 sc1
  v_mfma_f32_32x32x16_bf16 v[112:127], v[140:143], a[108:111], v[112:127]
  v_mfma_f32_32x32x16_bf16 v[112:127], v[144:147], a[112:115], v[112:127]
  buffer_load_dwordx4 v[168:171], v8, s[48:51], s82 offen offset:1024 sc1
  s_waitcnt lgkmcnt(0)
  v_mfma_f32_32x32x16_bf16 v[112:127], v[148:151], a[116:119], v[112:127]
  v_mfma_f32_32x32x16_bf16 v[112:127], v[152:155], a[120:123], v[112:127]
  buffer_load_dwordx4 v[172:175], v9, s[48:51], s82 offen offset:1024 sc1
  v_mfma_f32_32x32x16_bf16 v[112:127], v[156:159], a[124:127], v[112:127]
  buffer_load_dwordx4 v[176:179], v8, s[48:51], s83 offen offset:0 sc1
  buffer_load_dwordx4 v[180:183], v9, s[48:51], s83 offen offset:0 sc1
  buffer_load_dwordx4 v[184:187], v8, s[48:51], s83 offen offset:1024 sc1
  buffer_load_dwordx4 v[188:191], v9, s[48:51], s83 offen offset:1024 sc1
  s_nop 7
  v_pk_mul_f32 v[112:113], v[112:113], s[80:81] neg_lo:[1,0] neg_hi:[1,0]
  v_pk_mul_f32 v[114:115], v[114:115], s[80:81] neg_lo:[1,0] neg_hi:[1,0]
  v_pk_mul_f32 v[116:117], v[116:117], s[80:81] neg_lo:[1,0] neg_hi:[1,0]
  v_pk_mul_f32 v[118:119], v[118:119], s[80:81] neg_lo:[1,0] neg_hi:[1,0]
  v_exp_f32 v112, v112
  v_exp_f32 v113, v113
  v_exp_f32 v114, v114
  v_exp_f32 v115, v115
  v_exp_f32 v116, v116
  v_exp_f32 v117, v117
  v_exp_f32 v118, v118
  v_exp_f32 v119, v119
  v_pk_add_f32 v[112:113], v[112:113], 1.0 op_sel_hi:[1,0]
  v_pk_add_f32 v[114:115], v[114:115], 1.0 op_sel_hi:[1,0]
  v_pk_add_f32 v[116:117], v[116:117], 1.0 op_sel_hi:[1,0]
  v_pk_add_f32 v[118:119], v[118:119], 1.0 op_sel_hi:[1,0]
  v_rcp_f32 v112, v112
  v_rcp_f32 v113, v113
  v_rcp_f32 v114, v114
  v_rcp_f32 v115, v115
  v_rcp_f32 v116, v116
  v_rcp_f32 v117, v117
  v_rcp_f32 v118, v118
  v_rcp_f32 v119, v119
  v_pk_mul_f32 v[112:113], v[112:113], v[120:121]
  v_pk_mul_f32 v[114:115], v[114:115], v[122:123]
  v_pk_mul_f32 v[116:117], v[116:117], v[124:125]
  v_pk_mul_f32 v[118:119], v[118:119], v[126:127]
  v_cvt_pk_bf16_f32 v112, v112, v113
  v_cvt_pk_bf16_f32 v113, v114, v115
  v_cvt_pk_bf16_f32 v114, v116, v117
  v_cvt_pk_bf16_f32 v115, v118, v119
  buffer_store_dwordx4 v[112:115], v2, s[48:51], s72 offen offset:1024 sc1
  buffer_load_dwordx4 v[192:195], v8, s[48:51], s84 offen offset:0 sc1
  buffer_load_dwordx4 v[196:199], v9, s[48:51], s84 offen offset:0 sc1
L_g4:
  v_lshrrev_b32 v5, 5, v1
  s_waitcnt vmcnt(11)
  s_barrier
  ds_read_b64_tr_b16 v[128:129], v224 offset:32768
  ds_read_b64_tr_b16 v[130:131], v224 offset:33024
  ds_read_b64_tr_b16 v[132:133], v225 offset:32768
  ds_read_b64_tr_b16 v[134:135], v225 offset:33024
  ds_read_b64_tr_b16 v[136:137], v224 offset:40960
  ds_read_b64_tr_b16 v[138:139], v224 offset:41216
  ds_read_b64_tr_b16 v[140:141], v225 offset:40960
  ds_read_b64_tr_b16 v[142:143], v225 offset:41216
  ds_read_b64_tr_b16 v[144:145], v224 offset:49152
  ds_read_b64_tr_b16 v[146:147], v224 offset:49408
  ds_read_b64_tr_b16 v[148:149], v225 offset:49152
  ds_read_b64_tr_b16 v[150:151], v225 offset:49408
  buffer_load_dwordx4 v[200:203], v8, s[48:51], s84 offen offset:1024 sc1
  buffer_load_dwordx4 v[204:207], v9, s[48:51], s84 offen offset:1024 sc1
  s_waitcnt vmcnt(11) lgkmcnt(8)
  v_mfma_f32_32x32x16_bf16 v[32:47], v[128:131], v[160:163], 0
  v_mfma_f32_32x32x16_bf16 v[64:79], v[132:135], v[160:163], 0
  v_mfma_f32_32x32x16_bf16 v[48:63], v[128:131], v[164:167], 0
  v_mfma_f32_32x32x16_bf16 v[80:95], v[132:135], v[164:167], 0
  ds_read_b64_tr_b16 v[128:129], v224 offset:57344
  ds_read_b64_tr_b16 v[130:131], v224 offset:57600
  ds_read_b64_tr_b16 v[132:133], v225 offset:57344
  ds_read_b64_tr_b16 v[134:135], v225 offset:57600
  buffer_load_dwordx4 v[208:211], v8, s[48:51], s85 offen offset:0 sc1
  buffer_load_dwordx4 v[212:215], v9, s[48:51], s85 offen offset:0 sc1
  s_waitcnt vmcnt(11) lgkmcnt(8)
  v_mfma_f32_32x32x16_bf16 v[32:47], v[136:139], v[168:171], v[32:47]
  v_mfma_f32_32x32x16_bf16 v[64:79], v[140:143], v[168:171], v[64:79]
  v_mfma_f32_32x32x16_bf16 v[48:63], v[136:139], v[172:175], v[48:63]
  v_mfma_f32_32x32x16_bf16 v[80:95], v[140:143], v[172:175], v[80:95]
  ds_read_b64_tr_b16 v[136:137], v228 offset:16384
  ds_read_b64_tr_b16 v[138:139], v228 offset:16640
  ds_read_b64_tr_b16 v[140:141], v229 offset:16384
  ds_read_b64_tr_b16 v[142:143], v229 offset:16640
  buffer_load_dwordx4 v[216:219], v8, s[48:51], s85 offen offset:1024 sc1
  buffer_load_dwordx4 v[220:223], v9, s[48:51], s85 offen offset:1024 sc1
  s_waitcnt vmcnt(11) lgkmcnt(8)
  v_mfma_f32_32x32x16_bf16 v[32:47], v[144:147], v[176:179], v[32:47]
  v_mfma_f32_32x32x16_bf16 v[64:79], v[148:151], v[176:179], v[64:79]
  v_mfma_f32_32x32x16_bf16 v[48:63], v[144:147], v[180:183], v[48:63]
  v_mfma_f32_32x32x16_bf16 v[80:95], v[148:151], v[180:183], v[80:95]
  ds_read_b64_tr_b16 v[144:145], v228 offset:24576
  ds_read_b64_tr_b16 v[146:147], v228 offset:24832
  ds_read_b64_tr_b16 v[148:149], v229 offset:24576
  ds_read_b64_tr_b16 v[150:151], v229 offset:24832
  v_mov_b32 v3, 0
  v_mov_b32 v4, s56
  s_waitcnt vmcnt(8)
  s_mov_b64 exec, 1
  s_cmp_eq_u32 s57, 0
  s_cbranch_scc1 L_65
  buffer_store_dword v4, v3, s[48:51], s73 offen offset:768
  s_branch L_66
L_65:
  buffer_store_dword v4, v3, s[48:51], s73 offen offset:768 sc1
L_66:
  s_mov_b64 exec, -1
  buffer_load_dwordx4 a[128:131], v8, s[48:51], s86 offen offset:0 sc1
  buffer_load_dwordx4 a[132:135], v9, s[48:51], s86 offen offset:0 sc1
  s_waitcnt vmcnt(12) lgkmcnt(8)
  v_mfma_f32_32x32x16_bf16 v[32:47], v[128:131], v[184:187], v[32:47]
  v_mfma_f32_32x32x16_bf16 v[64:79], v[132:135], v[184:187], v[64:79]
  v_mfma_f32_32x32x16_bf16 v[48:63], v[128:131], v[188:191], v[48:63]
  v_mfma_f32_32x32x16_bf16 v[80:95], v[132:135], v[188:191], v[80:95]
  ds_read_b64_tr_b16 v[128:129], v226 offset:8192
  ds_read_b64_tr_b16 v[130:131], v226 offset:8448
  ds_read_b64_tr_b16 v[132:133], v227 offset:8192
  ds_read_b64_tr_b16 v[134:135], v227 offset:8448
  buffer_load_dwordx4 a[136:139], v8, s[48:51], s86 offen offset:1024 sc1
  buffer_load_dwordx4 a[140:143], v9, s[48:51], s86 offen offset:1024 sc1
  s_waitcnt vmcnt(11) lgkmcnt(8)
  v_mfma_f32_32x32x16_bf16 v[32:47], v[136:139], v[192:195], v[32:47]
  v_mfma_f32_32x32x16_bf16 v[64:79], v[140:143], v[192:195], v[64:79]
  v_mfma_f32_32x32x16_bf16 v[48:63], v[136:139], v[196:199], v[48:63]
  v_mfma_f32_32x32x16_bf16 v[80:95], v[140:143], v[196:199], v[80:95]
  ds_read_b64_tr_b16 v[136:137], v226 offset:49152
  ds_read_b64_tr_b16 v[138:139], v226 offset:49408
  ds_read_b64_tr_b16 v[140:141], v227 offset:49152
  ds_read_b64_tr_b16 v[142:143], v227 offset:49408
  buffer_load_dword v243, v230, s[48:51], s70 offen offset:768 sc1
  buffer_load_dwordx4 a[144:147], v8, s[48:51], s87 offen offset:0 sc1
  buffer_load_dwordx4 a[148:151], v9, s[48:51], s87 offen offset:0 sc1
  s_waitcnt vmcnt(12) lgkmcnt(8)
  v_mfma_f32_32x32x16_bf16 v[32:47], v[144:147], v[200:203], v[32:47]
  v_mfma_f32_32x32x16_bf16 v[64:79], v[148:151], v[200:203], v[64:79]
  v_mfma_f32_32x32x16_bf16 v[48:63], v[144:147], v[204:207], v[48:63]
  v_mfma_f32_32x32x16_bf16 v[80:95], v[148:151], v[204:207], v[80:95]
  ds_read_b64_tr_b16 v[144:145], v224 offset:0
  ds_read_b64_tr_b16 v[146:147], v224 offset:256
  ds_read_b64_tr_b16 v[148:149], v225 offset:0
  ds_read_b64_tr_b16 v[150:151], v225 offset:256
  buffer_load_dwordx4 a[152:155], v8, s[48:51], s87 offen offset:1024 sc1
  buffer_load_dwordx4 a[156:159], v9, s[48:51], s87 offen offset:1024 sc1
  s_waitcnt vmcnt(12) lgkmcnt(8)
  v_mfma_f32_32x32x16_bf16 v[32:47], v[128:131], v[208:211], v[32:47]
  v_mfma_f32_32x32x16_bf16 v[64:79], v[132:135], v[208:211], v[64:79]
  v_mfma_f32_32x32x16_bf16 v[48:63], v[128:131], v[212:215], v[48:63]
  v_mfma_f32_32x32x16_bf16 v[80:95], v[132:135], v[212:215], v[80:95]
  ds_read_b64_tr_b16 v[128:129], v226 offset:32768
  ds_read_b64_tr_b16 v[130:131], v226 offset:33024
  ds_read_b64_tr_b16 v[132:133], v227 offset:32768
  ds_read_b64_tr_b16 v[134:135], v227 offset:33024
  s_waitcnt vmcnt(10) lgkmcnt(8)
  v_mfma_f32_32x32x16_bf16 v[32:47], v[136:139], v[216:219], v[32:47]
  v_mfma_f32_32x32x16_bf16 v[64:79], v[140:143], v[216:219], v[64:79]
  v_mfma_f32_32x32x16_bf16 v[48:63], v[136:139], v[220:223], v[48:63]
  v_mfma_f32_32x32x16_bf16 v[80:95], v[140:143], v[220:223], v[80:95]
  ds_read_b64_tr_b16 v[136:137], v224 offset:8192
  ds_read_b64_tr_b16 v[138:139], v224 offset:8448
  ds_read_b64_tr_b16 v[140:141], v225 offset:8192
  ds_read_b64_tr_b16 v[142:143], v225 offset:8448
  s_mov_b32 s65, 0
  s_waitcnt vmcnt(4)
  v_cmp_ne_u32 vcc, s56, v243
  s_cbranch_vccz PD_67
  s_mov_b32 s65, 0
P_68:
  buffer_load_dword v243, v230, s[48:51], s70 offen offset:768 sc1
  s_add_u32 s65, s65, 1
  s_cmp_gt_u32 s65, 20000
  s_cbranch_scc1 PE_69
  s_waitcnt vmcnt(0)
  v_cmp_ne_u32 vcc, s56, v243
  s_cbranch_vccnz P_68
PE_69:
  s_waitcnt vmcnt(0)
PD_67:
  buffer_load_dwordx4 a[4:7], v9, s[48:51], s88 offen offset:0 sc1
  buffer_load_dwordx4 a[12:15], v9, s[48:51], s88 offen offset:1024 sc1
  buffer_load_dwordx4 a[20:23], v9, s[48:51], s96 offen offset:0 sc1
  buffer_load_dwordx4 a[28:31], v9, s[48:51], s96 offen offset:1024 sc1
  s_waitcnt vmcnt(11) lgkmcnt(8)
  v_mfma_f32_32x32x16_bf16 v[32:47], v[144:147], a[128:131], v[32:47]
  v_mfma_f32_32x32x16_bf16 v[64:79], v[148:151], a[128:131], v[64:79]
  v_mfma_f32_32x32x16_bf16 v[48:63], v[144:147], a[132:135], v[48:63]
  v_mfma_f32_32x32x16_bf16 v[80:95], v[148:151], a[132:135], v[80:95]
  buffer_load_dwordx4 a[36:39], v9, s[48:51], s97 offen offset:0 sc1
  buffer_load_dwordx4 a[44:47], v9, s[48:51], s97 offen offset:1024 sc1
  s_waitcnt vmcnt(11) lgkmcnt(4)
  v_mfma_f32_32x32x16_bf16 v[32:47], v[128:131], a[136:139], v[32:47]
  v_mfma_f32_32x32x16_bf16 v[64:79], v[132:135], a[136:139], v[64:79]
  v_mfma_f32_32x32x16_bf16 v[48:63], v[128:131], a[140:143], v[48:63]
  v_mfma_f32_32x32x16_bf16 v[80:95], v[132:135], a[140:143], v[80:95]
  buffer_load_dwordx4 a[52:55], v9, s[48:51], s98 offen offset:0 sc1
  buffer_load_dwordx4 a[60:63], v9, s[48:51], s98 offen offset:1024 sc1
  s_waitcnt vmcnt(10) lgkmcnt(0)
  v_mfma_f32_32x32x16_bf16 v[32:47], v[136:139], a[144:147], v[32:47]
  v_mfma_f32_32x32x16_bf16 v[64:79], v[140:143], a[144:147], v[64:79]
  v_mfma_f32_32x32x16_bf16 v[48:63], v[136:139], a[148:151], v[48:63]
  v_mfma_f32_32x32x16_bf16 v[80:95], v[140:143], a[148:151], v[80:95]
  buffer_load_dwordx4 a[68:71], v9, s[48:51], s99 offen offset:0 sc1
  buffer_load_dwordx4 a[76:79], v9, s[48:51], s99 offen offset:1024 sc1
  s_waitcnt vmcnt(10)
  v_mfma_f32_32x32x16_bf16 v[32:47], a[168:171], a[152:155], v[32:47]
  v_mfma_f32_32x32x16_bf16 v[64:79], a[172:175], a[152:155], v[64:79]
  v_mfma_f32_32x32x16_bf16 v[48:63], a[168:171], a[156:159], v[48:63]
  v_mfma_f32_32x32x16_bf16 v[80:95], a[172:175], a[156:159], v[80:95]
  s_xor_b32 s72, s60, 1
  s_lshl_b32 s72, s72, 12
  s_add_u32 s72, s72, 16384
  v_add_u32 v156, s72, v2
  s_xor_b32 s72, s60, 2
  s_lshl_b32 s72, s72, 12
  s_add_u32 s72, s72, 81920
  v_add_u32 v157, s72, v2
  s_xor_b32 s72, s60, 3
  s_lshl_b32 s72, s72, 12
  s_add_u32 s72, s72, 131072
  v_add_u32 v158, s72, v2
  buffer_load_dwordx4 a[0:3], v8, s[48:51], s88 offen offset:0 sc1
  s_waitcnt vmcnt(10)
  v_mfma_f32_32x32x16_bf16 v[80:95], a[180:183], a[4:7], v[80:95]
  v_mfma_f32_32x32x16_bf16 v[48:63], a[176:179], a[4:7], v[48:63]
  buffer_load_dwordx4 a[8:11], v8, s[48:51], s88 offen offset:1024 sc1
  s_waitcnt vmcnt(10)
  v_mfma_f32_32x32x16_bf16 v[80:95], a[188:191], a[12:15], v[80:95]
  v_mfma_f32_32x32x16_bf16 v[48:63], a[184:187], a[12:15], v[48:63]
  buffer_load_dwordx4 a[16:19], v8, s[48:51], s96 offen offset:0 sc1
  s_waitcnt vmcnt(10)
  v_mfma_f32_32x32x16_bf16 v[80:95], a[196:199], a[20:23], v[80:95]
  v_mfma_f32_32x32x16_bf16 v[48:63], a[192:195], a[20:23], v[48:63]
  buffer_load_dwordx4 a[24:27], v8, s[48:51], s96 offen offset:1024 sc1
  s_waitcnt vmcnt(10)
  v_mfma_f32_32x32x16_bf16 v[80:95], a[204:207], a[28:31], v[80:95]
  v_mfma_f32_32x32x16_bf16 v[48:63], a[200:203], a[28:31], v[48:63]
  buffer_load_dwordx4 a[32:35], v8, s[48:51], s97 offen offset:0 sc1
  s_waitcnt vmcnt(10)
  v_mfma_f32_32x32x16_bf16 v[80:95], a[212:215], a[36:39], v[80:95]
  v_mfma_f32_32x32x16_bf16 v[48:63], a[208:211], a[36:39], v[48:63]
  buffer_load_dwordx4 a[40:43], v8, s[48:51], s97 offen offset:1024 sc1
  s_waitcnt vmcnt(10)
  v_mfma_f32_32x32x16_bf16 v[80:95], a[220:223], a[44:47], v[80:95]
  v_mfma_f32_32x32x16_bf16 v[48:63], a[216:219], a[44:47], v[48:63]
  buffer_load_dwordx4 a[48:51], v8, s[48:51], s98 offen offset:0 sc1
  s_waitcnt vmcnt(10)
  v_mfma_f32_32x32x16_bf16 v[80:95], a[228:231], a[52:55], v[80:95]
  v_mfma_f32_32x32x16_bf16 v[48:63], a[224:227], a[52:55], v[48:63]
  buffer_load_dwordx4 a[56:59], v8, s[48:51], s98 offen offset:1024 sc1
  s_waitcnt vmcnt(10)
  v_mfma_f32_32x32x16_bf16 v[80:95], a[236:239], a[60:63], v[80:95]
  v_mfma_f32_32x32x16_bf16 v[48:63], a[232:235], a[60:63], v[48:63]
  buffer_load_dwordx4 a[64:67], v8, s[48:51], s99 offen offset:0 sc1
  s_waitcnt vmcnt(10)
  v_mfma_f32_32x32x16_bf16 v[80:95], a[244:247], a[68:71], v[80:95]
  v_mfma_f32_32x32x16_bf16 v[48:63], a[240:243], a[68:71], v[48:63]
  buffer_load_dwordx4 a[72:75], v8, s[48:51], s99 offen offset:1024 sc1
  s_waitcnt vmcnt(10)
  v_mfma_f32_32x32x16_bf16 v[80:95], a[252:255], a[76:79], v[80:95]
  v_mfma_f32_32x32x16_bf16 v[48:63], a[248:251], a[76:79], v[48:63]
  s_waitcnt vmcnt(9)
  v_mfma_f32_32x32x16_bf16 v[64:79], a[180:183], a[0:3], v[64:79]
  v_mfma_f32_32x32x16_bf16 v[32:47], a[176:179], a[0:3], v[32:47]
  s_waitcnt vmcnt(8)
  v_mfma_f32_32x32x16_bf16 v[64:79], a[188:191], a[8:11], v[64:79]
  v_mfma_f32_32x32x16_bf16 v[32:47], a[184:187], a[8:11], v[32:47]
  s_waitcnt vmcnt(7)
  v_mfma_f32_32x32x16_bf16 v[64:79], a[196:199], a[16:19], v[64:79]
  s_nop 2
  ds_write_b64 v158, v[80:81] offset:0
  v_mfma_f32_32x32x16_bf16 v[32:47], a[192:195], a[16:19], v[32:47]
  ds_write_b64 v158, v[82:83] offset:8
  s_waitcnt vmcnt(6)
  v_mfma_f32_32x32x16_bf16 v[64:79], a[204:207], a[24:27], v[64:79]
  ds_write_b64 v158, v[84:85] offset:1024
  v_mfma_f32_32x32x16_bf16 v[32:47], a[200:203], a[24:27], v[32:47]
  ds_write_b64 v158, v[86:87] offset:1032
  s_waitcnt vmcnt(5)
  v_mfma_f32_32x32x16_bf16 v[64:79], a[212:215], a[32:35], v[64:79]
  ds_write_b64 v158, v[88:89] offset:2048
  v_mfma_f32_32x32x16_bf16 v[32:47], a[208:211], a[32:35], v[32:47]
  ds_write_b64 v158, v[90:91] offset:2056
  s_waitcnt vmcnt(4)
  v_mfma_f32_32x32x16_bf16 v[64:79], a[220:223], a[40:43], v[64:79]
  ds_write_b64 v158, v[92:93] offset:3072
  v_mfma_f32_32x32x16_bf16 v[32:47], a[216:219], a[40:43], v[32:47]
  ds_write_b64 v158, v[94:95] offset:3080
  s_waitcnt vmcnt(3)
  v_mfma_f32_32x32x16_bf16 v[64:79], a[228:231], a[48:51], v[64:79]
  ds_write_b64 v156, v[48:49] offset:0
  v_mfma_f32_32x32x16_bf16 v[32:47], a[224:227], a[48:51], v[32:47]
  ds_write_b64 v156, v[50:51] offset:8
  s_waitcnt vmcnt(2)
  v_mfma_f32_32x32x16_bf16 v[64:79], a[236:239], a[56:59], v[64:79]
  ds_write_b64 v156, v[52:53] offset:1024
  v_mfma_f32_32x32x16_bf16 v[32:47], a[232:235], a[56:59], v[32:47]
  ds_write_b64 v156, v[54:55] offset:1032
  s_waitcnt vmcnt(1)
  v_mfma_f32_32x32x16_bf16 v[64:79], a[244:247], a[64:67], v[64:79]
  ds_write_b64 v156, v[56:57] offset:2048
  ds_write_b64 v156, v[58:59] offset:2056
  s_waitcnt vmcnt(0)
  v_mfma_f32_32x32x16_bf16 v[64:79], a[252:255], a[72:75], v[64:79]
  ds_write_b64 v156, v[60:61] offset:3072
  ds_write_b64 v156, v[62:63] offset:3080
  v_mfma_f32_32x32x16_bf16 v[32:47], a[240:243], a[64:67], v[32:47]
  v_mfma_f32_32x32x16_bf16 v[32:47], a[248:251], a[72:75], v[32:47]
  s_nop 7
  ds_write_b64 v157, v[64:65] offset:0
  ds_write_b64 v157, v[66:67] offset:8
  ds_write_b64 v157, v[68:69] offset:1024
  ds_write_b64 v157, v[70:71] offset:1032
  ds_write_b64 v157, v[72:73] offset:2048
  ds_write_b64 v157, v[74:75] offset:2056
  ds_write_b64 v157, v[76:77] offset:3072
  ds_write_b64 v157, v[78:79] offset:3080
  v_lshlrev_b32 v104, 16, v232
  v_and_b32 v105, 0xffff0000, v232
  v_lshlrev_b32 v106, 16, v233
  v_and_b32 v107, 0xffff0000, v233
  v_lshlrev_b32 v108, 16, v234
  v_and_b32 v109, 0xffff0000, v234
  v_lshlrev_b32 v110, 16, v235
  v_and_b32 v111, 0xffff0000, v235
  v_lshlrev_b32 v112, 16, v236
  v_and_b32 v113, 0xffff0000, v236
  v_lshlrev_b32 v114, 16, v237
  v_and_b32 v115, 0xffff0000, v237
  v_lshlrev_b32 v116, 16, v238
  v_and_b32 v117, 0xffff0000, v238
  v_lshlrev_b32 v118, 16, v239
  v_and_b32 v119, 0xffff0000, v239
  s_lshl_b32 s72, s60, 12
  v_add_u32 v8, s72, v2
  v_add_u32 v9, 0x10000, v8
  v_add_u32 v10, 0x20000, v8
  v_mov_b32 v3, v5
  s_waitcnt lgkmcnt(0)
  s_barrier
  ds_read_b128 v[48:51], v8 offset:16384
  ds_read_b128 v[52:55], v8 offset:17408
  ds_read_b128 v[56:59], v8 offset:18432
  ds_read_b128 v[60:63], v8 offset:19456
  ds_read_b128 v[64:67], v9 offset:16384
  ds_read_b128 v[68:71], v9 offset:17408
  ds_read_b128 v[72:75], v9 offset:18432
  ds_read_b128 v[76:79], v9 offset:19456
  ds_read_b128 v[80:83], v10 offset:0
  ds_read_b128 v[84:87], v10 offset:1024
  ds_read_b128 v[88:91], v10 offset:2048
  ds_read_b128 v[92:95], v10 offset:3072
  v_and_b32 v8, 31, v1
  v_mul_u32_u24 v8, 144, v8
  v_lshl_add_u32 v8, v3, 4, v8
  s_mul_i32 s72, s74, 4608
  s_lshl_b32 s73, s75, 6
  s_add_u32 s72, s72, s73
  s_add_u32 s72, s72, 0
  v_add_u32 v8, s72, v8
  v_lshrrev_b32 v9, 3, v1
  v_and_b32 v10, 7, v1
  v_mul_u32_u24 v11, 144, v9
  v_lshl_add_u32 v11, v10, 4, v11
  s_mul_i32 s72, s60, 2304
  s_add_u32 s72, s72, 0
  v_add_u32 v11, s72, v11
  v_lshlrev_b32 v9, 10, v9
  v_lshl_add_u32 v9, v10, 4, v9
  s_lshl_b32 s72, s58, 17
  s_lshr_b32 s73, s59, 3
  s_lshl_b32 s73, s73, 16
  s_add_u32 s72, s72, s73
  s_lshl_b32 s73, s60, 14
  s_add_u32 s72, s72, s73
  s_and_b32 s73, s59, 7
  s_lshl_b32 s73, s73, 7
  s_add_u32 s72, s72, s73
  s_add_u32 s73, s72, 8192
  s_waitcnt lgkmcnt(8)
  v_pk_add_f32 v[32:33], v[32:33], v[48:49]
  v_pk_add_f32 v[34:35], v[34:35], v[50:51]
  v_pk_add_f32 v[36:37], v[36:37], v[52:53]
  v_pk_add_f32 v[38:39], v[38:39], v[54:55]
  v_pk_add_f32 v[40:41], v[40:41], v[56:57]
  v_pk_add_f32 v[42:43], v[42:43], v[58:59]
  v_pk_add_f32 v[44:45], v[44:45], v[60:61]
  v_pk_add_f32 v[46:47], v[46:47], v[62:63]
  s_waitcnt lgkmcnt(4)
  v_pk_add_f32 v[32:33], v[32:33], v[64:65]
  v_pk_add_f32 v[34:35], v[34:35], v[66:67]
  v_pk_add_f32 v[36:37], v[36:37], v[68:69]
  v_pk_add_f32 v[38:39], v[38:39], v[70:71]
  v_pk_add_f32 v[40:41], v[40:41], v[72:73]
  v_pk_add_f32 v[42:43], v[42:43], v[74:75]
  v_pk_add_f32 v[44:45], v[44:45], v[76:77]
  v_pk_add_f32 v[46:47], v[46:47], v[78:79]
  s_waitcnt lgkmcnt(0)
  v_pk_add_f32 v[32:33], v[32:33], v[80:81]
  v_pk_add_f32 v[34:35], v[34:35], v[82:83]
  v_pk_add_f32 v[36:37], v[36:37], v[84:85]
  v_pk_add_f32 v[38:39], v[38:39], v[86:87]
  v_pk_add_f32 v[40:41], v[40:41], v[88:89]
  v_pk_add_f32 v[42:43], v[42:43], v[90:91]
  v_pk_add_f32 v[44:45], v[44:45], v[92:93]
  v_pk_add_f32 v[46:47], v[46:47], v[94:95]
  v_pk_fma_f32 v[16:17], v[32:33], v[104:105], v[16:17]
  v_pk_fma_f32 v[18:19], v[34:35], v[106:107], v[18:19]
  v_pk_fma_f32 v[20:21], v[36:37], v[108:109], v[20:21]
  v_pk_fma_f32 v[22:23], v[38:39], v[110:111], v[22:23]
  v_pk_fma_f32 v[24:25], v[40:41], v[112:113], v[24:25]
  v_pk_fma_f32 v[26:27], v[42:43], v[114:115], v[26:27]
  v_pk_fma_f32 v[28:29], v[44:45], v[116:117], v[28:29]
  v_pk_fma_f32 v[30:31], v[46:47], v[118:119], v[30:31]
  v_cvt_pk_bf16_f32 v16, v16, v17
  v_cvt_pk_bf16_f32 v17, v18, v19
  v_cvt_pk_bf16_f32 v18, v20, v21
  v_cvt_pk_bf16_f32 v19, v22, v23
  v_cvt_pk_bf16_f32 v20, v24, v25
  v_cvt_pk_bf16_f32 v21, v26, v27
  v_cvt_pk_bf16_f32 v22, v28, v29
  v_cvt_pk_bf16_f32 v23, v30, v31
  ds_write_b128 v8, v[16:19]
  ds_write_b128 v8, v[20:23] offset:32
  s_waitcnt lgkmcnt(0)
  s_barrier
  ds_read_b128 v[32:35], v11
  ds_read_b128 v[36:39], v11 offset:1152
  s_waitcnt lgkmcnt(1)
  buffer_store_dwordx4 v[32:35], v9, s[44:47], s72 offen nt
  s_waitcnt lgkmcnt(0)
  buffer_store_dwordx4 v[36:39], v9, s[44:47], s73 offen nt
L_end:
  s_endpgm
L_code_end:
.fill 849, 4, 0xbf810000
.section .rodata,"a"
.p2align 6
.amdhsa_kernel adaLN_cond__linear_kernel_hedgehog__glu_gated_glu__prompt_kernel
  .amdhsa_next_free_vgpr 512
  .amdhsa_next_free_sgpr 102
  .amdhsa_accum_offset 256
  .amdhsa_group_segment_fixed_size 0
  .amdhsa_kernarg_size 104
  .amdhsa_user_sgpr_count 2
  .amdhsa_user_sgpr_kernarg_segment_ptr 1
  .amdhsa_system_sgpr_workgroup_id_x 1
.end_amdhsa_kernel
```
